```python
import torch

def _softmax(x, axis=-1):
    return torch.softmax(x, dim=axis)

def _gelu(x):
    return torch.nn.functional.gelu(x, approximate='tanh')

def _silu(x):
    return torch.nn.functional.silu(x)

def _sigmoid(x):
    return torch.sigmoid(x)

def _layernorm(x, axis=-1, eps=1e-05):
    m = x.mean(dim=axis, keepdim=True)
    v = x.var(dim=axis, keepdim=True, unbiased=False)
    return (x - m) / torch.sqrt(v + eps)

def _scatter_add(tgt, idx, src, axis=0):
    return tgt.clone().index_add_(axis, idx, src)

def _segment_sum(src, seg, n):
    out = torch.zeros((n,) + src.shape[1:], dtype=src.dtype)
    return out.index_add_(0, seg, src)

def _pad(x, pw):
    flat = tuple((v for pair in reversed(pw) for v in pair))
    return torch.nn.functional.pad(x, flat)
kernel_name = 'standalone__autoregressive_conv_wavenet__speech'

def setup_inputs():

    _w = lambda a: (lambda t: t.to(torch.bfloat16) if t.is_floating_point() else t)(torch.as_tensor(a))
    B, T, D, K = (2, 4000, 256, 3)
    return {'x': _w((lambda *s: torch.randn(*s, dtype=torch.bfloat16) * 0.1)(B, T, D)), 'w': _w((lambda *s: torch.randn(*s, dtype=torch.bfloat16) * 0.1)(K, D, 2 * D)), 'w_o': _w((lambda *s: torch.randn(*s, dtype=torch.bfloat16) * 0.05)(D, D))}

def reference(x, w, w_o):
    B, T, D = x.shape
    K = w.shape[0]
    dil = 2
    pad = (K - 1) * dil
    xp = _pad(x, ((0, 0), (pad, 0), (0, 0)))
    h = torch.einsum('btc,cd->btd', xp[:, pad:pad + T, :], w[0])
    for i in range(1, K):
        off = pad - i * dil
        h = h + torch.einsum('btc,cd->btd', xp[:, off:off + T, :], w[i])
    f = h[..., :D].clone()
    g = h[..., D:].clone()
    z = torch.tanh(f) * _sigmoid(g)
    return z @ w_o
```

```asm
; @launch kernel=wn_conv_kernel grid=(256,1,1) block=(256,1,1) lds=121088
; @launch kernel=wn_out_kernel grid=(256,1,1) block=(256,1,1) lds=99584
.amdgcn_target "amdgcn-amd-amdhsa--gfx950"
.text
.globl wn_conv_kernel
.p2align 8
.type wn_conv_kernel,@function
wn_conv_kernel:
s_cmp_ge_u32 s2, 256
s_cbranch_scc1 L_end
s_load_dwordx4 s[4:7], s[0:1], 0
s_load_dwordx4 s[48:51], s[0:1], 16
s_load_dwordx4 s[52:55], s[0:1], 32
s_and_b32 s24, s2, 7
s_lshr_b32 s25, s2, 3
s_lshr_b32 s26, s25, 2
s_lshl_b32 s27, s24, 3
s_add_u32 s26, s26, s27
s_and_b32 s27, s25, 3
s_lshr_b32 s28, s26, 5
s_and_b32 s29, s26, 31
s_mul_i32 s30, s28, 2048000
v_lshrrev_b32 v1, 6, v0
v_and_b32 v2, 63, v0
s_nop 0
v_readfirstlane_b32 s31, v1
s_waitcnt lgkmcnt(0)
s_add_u32 s12, s4, s30
s_addc_u32 s13, s5, 0
s_mov_b32 s14, 2048000
s_mov_b32 s15, 0x00020000
s_mov_b32 s16, s6
s_mov_b32 s17, s7
s_mov_b32 s18, 786432
s_mov_b32 s19, 0x00020000
s_add_u32 s20, s54, s30
s_addc_u32 s21, s55, 0
s_mov_b32 s22, 2048000
s_mov_b32 s23, 0x00020000
s_lshr_b32 s32, s31, 1
s_and_b32 s33, s31, 1
s_lshl_b32 s34, s29, 16
s_sub_u32 s34, s34, 2048
v_lshlrev_b32 v3, 4, v0
v_add_u32 v3, s34, v3
buffer_load_dwordx4 v[56:59], v3, s[12:15], 0 offen
v_add_u32 v3, 0x1000, v3
buffer_load_dwordx4 v[60:63], v3, s[12:15], 0 offen
v_add_u32 v3, 0x1000, v3
buffer_load_dwordx4 v[64:67], v3, s[12:15], 0 offen
v_add_u32 v3, 0x1000, v3
buffer_load_dwordx4 v[68:71], v3, s[12:15], 0 offen
v_add_u32 v3, 0x1000, v3
buffer_load_dwordx4 v[72:75], v3, s[12:15], 0 offen
v_add_u32 v3, 0x1000, v3
buffer_load_dwordx4 v[76:79], v3, s[12:15], 0 offen
v_add_u32 v3, 0x1000, v3
buffer_load_dwordx4 v[80:83], v3, s[12:15], 0 offen
v_add_u32 v3, 0x1000, v3
buffer_load_dwordx4 v[84:87], v3, s[12:15], 0 offen
v_add_u32 v3, 0x1000, v3
buffer_load_dwordx4 v[88:91], v3, s[12:15], 0 offen
v_add_u32 v3, 0x1000, v3
buffer_load_dwordx4 v[92:95], v3, s[12:15], 0 offen
v_add_u32 v3, 0x1000, v3
buffer_load_dwordx4 v[96:99], v3, s[12:15], 0 offen
v_add_u32 v3, 0x1000, v3
buffer_load_dwordx4 v[100:103], v3, s[12:15], 0 offen
v_add_u32 v3, 0x1000, v3
buffer_load_dwordx4 v[104:107], v3, s[12:15], 0 offen
v_add_u32 v3, 0x1000, v3
buffer_load_dwordx4 v[108:111], v3, s[12:15], 0 offen
v_add_u32 v3, 0x1000, v3
buffer_load_dwordx4 v[112:115], v3, s[12:15], 0 offen
v_add_u32 v3, 0x1000, v3
buffer_load_dwordx4 v[116:119], v3, s[12:15], 0 offen
v_add_u32 v3, 0x1000, v3
buffer_load_dwordx4 v[120:123], v3, s[12:15], 0 offen
v_and_b32 v4, 15, v0
v_lshrrev_b32 v5, 4, v0
v_and_b32 v6, 3, v5
v_lshlrev_b32 v6, 2, v6
v_xor_b32 v4, v4, v6
v_and_b32 v6, 7, v4
v_lshlrev_b32 v6, 4, v6
v_lshrrev_b32 v7, 3, v4
v_lshlrev_b32 v7, 9, v7
v_add_u32 v6, v6, v7
v_lshlrev_b32 v5, 10, v5
v_add_u32 v6, v6, v5
s_lshl_b32 s35, s27, 7
v_add_u32 v4, s35, v6
v_lshlrev_b32 v5, 4, v0
v_add_u32 v5, 71936, v5
s_mov_b32 s36, 0
buffer_load_dwordx4 v[124:127], v4, s[16:19], s36 offen
s_mov_b32 s36, 16384
buffer_load_dwordx4 v[128:131], v4, s[16:19], s36 offen
s_mov_b32 s36, 32768
buffer_load_dwordx4 v[132:135], v4, s[16:19], s36 offen
s_mov_b32 s36, 49152
buffer_load_dwordx4 v[136:139], v4, s[16:19], s36 offen
s_mov_b32 s36, 65536
buffer_load_dwordx4 v[140:143], v4, s[16:19], s36 offen
s_mov_b32 s36, 81920
buffer_load_dwordx4 v[144:147], v4, s[16:19], s36 offen
s_mov_b32 s36, 98304
buffer_load_dwordx4 v[148:151], v4, s[16:19], s36 offen
s_mov_b32 s36, 114688
buffer_load_dwordx4 v[152:155], v4, s[16:19], s36 offen
s_mov_b32 s36, 131072
buffer_load_dwordx4 v[40:43], v4, s[16:19], s36 offen
s_mov_b32 s36, 147456
buffer_load_dwordx4 v[44:47], v4, s[16:19], s36 offen
s_mov_b32 s36, 163840
buffer_load_dwordx4 v[48:51], v4, s[16:19], s36 offen
s_mov_b32 s36, 180224
buffer_load_dwordx4 v[52:55], v4, s[16:19], s36 offen
s_mov_b32 s36, 196608
buffer_load_dwordx4 v[24:27], v4, s[16:19], s36 offen
s_mov_b32 s36, 212992
buffer_load_dwordx4 v[28:31], v4, s[16:19], s36 offen
s_mov_b32 s36, 229376
buffer_load_dwordx4 v[32:35], v4, s[16:19], s36 offen
s_mov_b32 s36, 245760
buffer_load_dwordx4 v[36:39], v4, s[16:19], s36 offen
v_lshrrev_b32 v6, 5, v0
v_mul_u32_u24 v6, 528, v6
v_and_b32 v7, 31, v0
v_lshlrev_b32 v7, 4, v7
v_add_u32 v6, v6, v7
v_add_u32 v7, 67584, v6
v_and_b32 v8, 31, v2
s_lshl_b32 s36, s32, 6
v_add_u32 v8, s36, v8
v_mul_u32_u24 v8, 528, v8
v_lshrrev_b32 v9, 5, v2
v_lshlrev_b32 v10, 4, v9
v_add_u32 v8, v8, v10
v_and_b32 v10, 15, v2
v_lshrrev_b32 v10, 2, v10
v_and_b32 v11, 3, v2
v_lshrrev_b32 v12, 4, v2
v_and_b32 v12, 1, v12
v_lshlrev_b32 v13, 1, v12
v_lshrrev_b32 v14, 1, v11
v_add_u32 v13, v13, v14
v_lshlrev_b32 v14, 2, v10
v_xor_b32 v15, v13, v14
v_lshlrev_b32 v15, 4, v15
v_and_b32 v14, 1, v11
v_lshlrev_b32 v14, 3, v14
v_add_u32 v15, v15, v14
v_lshlrev_b32 v14, 3, v9
v_add_u32 v14, v14, v10
v_lshlrev_b32 v16, 9, v14
v_add_u32 v16, v16, v15
v_lshlrev_b32 v14, 8, v14
v_add_u32 v13, v15, v14
s_lshl_b32 s36, s33, 6
v_xor_b32 v13, s36, v13
v_add_u32 v10, 71936, v13
v_xor_b32 v11, 0x80, v10
v_mov_b32 v192, 0
v_mov_b32 v193, 0
v_mov_b32 v194, 0
v_mov_b32 v195, 0
v_mov_b32 v196, 0
v_mov_b32 v197, 0
v_mov_b32 v198, 0
v_mov_b32 v199, 0
v_mov_b32 v200, 0
v_mov_b32 v201, 0
v_mov_b32 v202, 0
v_mov_b32 v203, 0
v_mov_b32 v204, 0
v_mov_b32 v205, 0
v_mov_b32 v206, 0
v_mov_b32 v207, 0
v_mov_b32 v208, 0
v_mov_b32 v209, 0
v_mov_b32 v210, 0
v_mov_b32 v211, 0
v_mov_b32 v212, 0
v_mov_b32 v213, 0
v_mov_b32 v214, 0
v_mov_b32 v215, 0
v_mov_b32 v216, 0
v_mov_b32 v217, 0
v_mov_b32 v218, 0
v_mov_b32 v219, 0
v_mov_b32 v220, 0
v_mov_b32 v221, 0
v_mov_b32 v222, 0
v_mov_b32 v223, 0
v_mov_b32 v224, 0
v_mov_b32 v225, 0
v_mov_b32 v226, 0
v_mov_b32 v227, 0
v_mov_b32 v228, 0
v_mov_b32 v229, 0
v_mov_b32 v230, 0
v_mov_b32 v231, 0
v_mov_b32 v232, 0
v_mov_b32 v233, 0
v_mov_b32 v234, 0
v_mov_b32 v235, 0
v_mov_b32 v236, 0
v_mov_b32 v237, 0
v_mov_b32 v238, 0
v_mov_b32 v239, 0
v_mov_b32 v240, 0
v_mov_b32 v241, 0
v_mov_b32 v242, 0
v_mov_b32 v243, 0
v_mov_b32 v244, 0
v_mov_b32 v245, 0
v_mov_b32 v246, 0
v_mov_b32 v247, 0
v_mov_b32 v248, 0
v_mov_b32 v249, 0
v_mov_b32 v250, 0
v_mov_b32 v251, 0
v_mov_b32 v252, 0
v_mov_b32 v253, 0
v_mov_b32 v254, 0
v_mov_b32 v255, 0
s_waitcnt vmcnt(16)
ds_write_b128 v6, v[56:59] offset:0
ds_write_b128 v6, v[60:63] offset:4224
ds_write_b128 v6, v[64:67] offset:8448
ds_write_b128 v6, v[68:71] offset:12672
ds_write_b128 v6, v[72:75] offset:16896
ds_write_b128 v6, v[76:79] offset:21120
ds_write_b128 v6, v[80:83] offset:25344
ds_write_b128 v6, v[84:87] offset:29568
ds_write_b128 v6, v[88:91] offset:33792
ds_write_b128 v6, v[92:95] offset:38016
ds_write_b128 v6, v[96:99] offset:42240
ds_write_b128 v6, v[100:103] offset:46464
ds_write_b128 v6, v[104:107] offset:50688
ds_write_b128 v6, v[108:111] offset:54912
ds_write_b128 v6, v[112:115] offset:59136
ds_write_b128 v6, v[116:119] offset:63360
ds_write_b128 v7, v[120:123]
s_waitcnt vmcnt(12)
ds_write_b128 v5, v[124:127] offset:0
ds_write_b128 v5, v[128:131] offset:4096
ds_write_b128 v5, v[132:135] offset:8192
ds_write_b128 v5, v[136:139] offset:12288
s_waitcnt vmcnt(8)
ds_write_b128 v5, v[140:143] offset:16384
ds_write_b128 v5, v[144:147] offset:20480
ds_write_b128 v5, v[148:151] offset:24576
ds_write_b128 v5, v[152:155] offset:28672
s_waitcnt lgkmcnt(0)
s_barrier
ds_read_b128 v[160:163], v8 offset:2112
ds_read_b64_tr_b16 v[168:169], v10 offset:0
ds_read_b64_tr_b16 v[170:171], v10 offset:1024
ds_read_b64_tr_b16 v[172:173], v11 offset:0
ds_read_b64_tr_b16 v[174:175], v11 offset:1024
ds_read_b128 v[164:167], v8 offset:19008
s_waitcnt lgkmcnt(3)
v_mfma_f32_32x32x16_bf16 v[192:207], v[168:171], v[160:163], v[192:207]
ds_read_b128 v[176:179], v8 offset:2144
ds_read_b64_tr_b16 v[184:185], v10 offset:4096
ds_read_b64_tr_b16 v[186:187], v10 offset:5120
s_waitcnt lgkmcnt(4)
v_mfma_f32_32x32x16_bf16 v[208:223], v[172:175], v[160:163], v[208:223]
ds_read_b64_tr_b16 v[188:189], v11 offset:4096
ds_read_b64_tr_b16 v[190:191], v11 offset:5120
s_waitcnt lgkmcnt(5)
v_mfma_f32_32x32x16_bf16 v[224:239], v[168:171], v[164:167], v[224:239]
ds_read_b128 v[180:183], v8 offset:19040
s_mov_b32 s36, 262144
buffer_load_dwordx4 v[124:127], v4, s[16:19], s36 offen
v_mfma_f32_32x32x16_bf16 v[240:255], v[172:175], v[164:167], v[240:255]
s_waitcnt vmcnt(4)
ds_write_b128 v5, v[40:43] offset:32768
s_waitcnt lgkmcnt(4)
v_mfma_f32_32x32x16_bf16 v[192:207], v[184:187], v[176:179], v[192:207]
ds_read_b128 v[160:163], v8 offset:2176
ds_read_b64_tr_b16 v[168:169], v10 offset:8192
ds_read_b64_tr_b16 v[170:171], v10 offset:9216
s_waitcnt lgkmcnt(5)
v_mfma_f32_32x32x16_bf16 v[208:223], v[188:191], v[176:179], v[208:223]
ds_read_b64_tr_b16 v[172:173], v11 offset:8192
ds_read_b64_tr_b16 v[174:175], v11 offset:9216
s_waitcnt lgkmcnt(6)
v_mfma_f32_32x32x16_bf16 v[224:239], v[184:187], v[180:183], v[224:239]
ds_read_b128 v[164:167], v8 offset:19072
s_mov_b32 s36, 278528
buffer_load_dwordx4 v[128:131], v4, s[16:19], s36 offen
v_mfma_f32_32x32x16_bf16 v[240:255], v[188:191], v[180:183], v[240:255]
ds_write_b128 v5, v[44:47] offset:36864
s_waitcnt lgkmcnt(4)
v_mfma_f32_32x32x16_bf16 v[192:207], v[168:171], v[160:163], v[192:207]
ds_read_b128 v[176:179], v8 offset:2208
ds_read_b64_tr_b16 v[184:185], v10 offset:12288
ds_read_b64_tr_b16 v[186:187], v10 offset:13312
s_waitcnt lgkmcnt(5)
v_mfma_f32_32x32x16_bf16 v[208:223], v[172:175], v[160:163], v[208:223]
ds_read_b64_tr_b16 v[188:189], v11 offset:12288
ds_read_b64_tr_b16 v[190:191], v11 offset:13312
s_waitcnt lgkmcnt(6)
v_mfma_f32_32x32x16_bf16 v[224:239], v[168:171], v[164:167], v[224:239]
ds_read_b128 v[180:183], v8 offset:19104
s_mov_b32 s36, 294912
buffer_load_dwordx4 v[132:135], v4, s[16:19], s36 offen
v_mfma_f32_32x32x16_bf16 v[240:255], v[172:175], v[164:167], v[240:255]
ds_write_b128 v5, v[48:51] offset:40960
s_waitcnt lgkmcnt(4)
v_mfma_f32_32x32x16_bf16 v[192:207], v[184:187], v[176:179], v[192:207]
ds_read_b128 v[160:163], v8 offset:2240
ds_read_b64_tr_b16 v[168:169], v10 offset:16384
ds_read_b64_tr_b16 v[170:171], v10 offset:17408
s_waitcnt lgkmcnt(5)
v_mfma_f32_32x32x16_bf16 v[208:223], v[188:191], v[176:179], v[208:223]
ds_read_b64_tr_b16 v[172:173], v11 offset:16384
ds_read_b64_tr_b16 v[174:175], v11 offset:17408
s_waitcnt lgkmcnt(6)
v_mfma_f32_32x32x16_bf16 v[224:239], v[184:187], v[180:183], v[224:239]
ds_read_b128 v[164:167], v8 offset:19136
s_mov_b32 s36, 311296
buffer_load_dwordx4 v[136:139], v4, s[16:19], s36 offen
v_mfma_f32_32x32x16_bf16 v[240:255], v[188:191], v[180:183], v[240:255]
ds_write_b128 v5, v[52:55] offset:45056
s_barrier
s_waitcnt lgkmcnt(4)
v_mfma_f32_32x32x16_bf16 v[192:207], v[168:171], v[160:163], v[192:207]
ds_read_b128 v[176:179], v8 offset:2272
ds_read_b64_tr_b16 v[184:185], v10 offset:20480
ds_read_b64_tr_b16 v[186:187], v10 offset:21504
s_waitcnt lgkmcnt(5)
v_mfma_f32_32x32x16_bf16 v[208:223], v[172:175], v[160:163], v[208:223]
ds_read_b64_tr_b16 v[188:189], v11 offset:20480
ds_read_b64_tr_b16 v[190:191], v11 offset:21504
s_waitcnt lgkmcnt(6)
v_mfma_f32_32x32x16_bf16 v[224:239], v[168:171], v[164:167], v[224:239]
ds_read_b128 v[180:183], v8 offset:19168
s_mov_b32 s36, 327680
buffer_load_dwordx4 v[140:143], v4, s[16:19], s36 offen
v_mfma_f32_32x32x16_bf16 v[240:255], v[172:175], v[164:167], v[240:255]
s_waitcnt vmcnt(4)
ds_write_b128 v5, v[24:27] offset:0
s_waitcnt lgkmcnt(4)
v_mfma_f32_32x32x16_bf16 v[192:207], v[184:187], v[176:179], v[192:207]
ds_read_b128 v[160:163], v8 offset:2304
ds_read_b64_tr_b16 v[168:169], v10 offset:24576
ds_read_b64_tr_b16 v[170:171], v10 offset:25600
s_waitcnt lgkmcnt(5)
v_mfma_f32_32x32x16_bf16 v[208:223], v[188:191], v[176:179], v[208:223]
ds_read_b64_tr_b16 v[172:173], v11 offset:24576
ds_read_b64_tr_b16 v[174:175], v11 offset:25600
s_waitcnt lgkmcnt(6)
v_mfma_f32_32x32x16_bf16 v[224:239], v[184:187], v[180:183], v[224:239]
ds_read_b128 v[164:167], v8 offset:19200
s_mov_b32 s36, 344064
buffer_load_dwordx4 v[144:147], v4, s[16:19], s36 offen
v_mfma_f32_32x32x16_bf16 v[240:255], v[188:191], v[180:183], v[240:255]
ds_write_b128 v5, v[28:31] offset:4096
s_waitcnt lgkmcnt(4)
v_mfma_f32_32x32x16_bf16 v[192:207], v[168:171], v[160:163], v[192:207]
ds_read_b128 v[176:179], v8 offset:2336
ds_read_b64_tr_b16 v[184:185], v10 offset:28672
ds_read_b64_tr_b16 v[186:187], v10 offset:29696
s_waitcnt lgkmcnt(5)
v_mfma_f32_32x32x16_bf16 v[208:223], v[172:175], v[160:163], v[208:223]
ds_read_b64_tr_b16 v[188:189], v11 offset:28672
ds_read_b64_tr_b16 v[190:191], v11 offset:29696
s_waitcnt lgkmcnt(6)
v_mfma_f32_32x32x16_bf16 v[224:239], v[168:171], v[164:167], v[224:239]
ds_read_b128 v[180:183], v8 offset:19232
s_mov_b32 s36, 360448
buffer_load_dwordx4 v[148:151], v4, s[16:19], s36 offen
v_mfma_f32_32x32x16_bf16 v[240:255], v[172:175], v[164:167], v[240:255]
ds_write_b128 v5, v[32:35] offset:8192
s_waitcnt lgkmcnt(4)
v_mfma_f32_32x32x16_bf16 v[192:207], v[184:187], v[176:179], v[192:207]
ds_read_b128 v[160:163], v8 offset:2368
ds_read_b64_tr_b16 v[168:169], v10 offset:32768
ds_read_b64_tr_b16 v[170:171], v10 offset:33792
s_waitcnt lgkmcnt(5)
v_mfma_f32_32x32x16_bf16 v[208:223], v[188:191], v[176:179], v[208:223]
ds_read_b64_tr_b16 v[172:173], v11 offset:32768
ds_read_b64_tr_b16 v[174:175], v11 offset:33792
s_waitcnt lgkmcnt(6)
v_mfma_f32_32x32x16_bf16 v[224:239], v[184:187], v[180:183], v[224:239]
ds_read_b128 v[164:167], v8 offset:19264
s_mov_b32 s36, 376832
buffer_load_dwordx4 v[152:155], v4, s[16:19], s36 offen
v_mfma_f32_32x32x16_bf16 v[240:255], v[188:191], v[180:183], v[240:255]
ds_write_b128 v5, v[36:39] offset:12288
s_barrier
s_waitcnt lgkmcnt(4)
v_mfma_f32_32x32x16_bf16 v[192:207], v[168:171], v[160:163], v[192:207]
ds_read_b128 v[176:179], v8 offset:2400
ds_read_b64_tr_b16 v[184:185], v10 offset:36864
ds_read_b64_tr_b16 v[186:187], v10 offset:37888
s_waitcnt lgkmcnt(5)
v_mfma_f32_32x32x16_bf16 v[208:223], v[172:175], v[160:163], v[208:223]
ds_read_b64_tr_b16 v[188:189], v11 offset:36864
ds_read_b64_tr_b16 v[190:191], v11 offset:37888
s_waitcnt lgkmcnt(6)
v_mfma_f32_32x32x16_bf16 v[224:239], v[168:171], v[164:167], v[224:239]
ds_read_b128 v[180:183], v8 offset:19296
s_mov_b32 s36, 393216
buffer_load_dwordx4 v[40:43], v4, s[16:19], s36 offen
v_mfma_f32_32x32x16_bf16 v[240:255], v[172:175], v[164:167], v[240:255]
s_waitcnt vmcnt(4)
ds_write_b128 v5, v[124:127] offset:16384
s_waitcnt lgkmcnt(4)
v_mfma_f32_32x32x16_bf16 v[192:207], v[184:187], v[176:179], v[192:207]
ds_read_b128 v[160:163], v8 offset:2432
ds_read_b64_tr_b16 v[168:169], v10 offset:40960
ds_read_b64_tr_b16 v[170:171], v10 offset:41984
s_waitcnt lgkmcnt(5)
v_mfma_f32_32x32x16_bf16 v[208:223], v[188:191], v[176:179], v[208:223]
ds_read_b64_tr_b16 v[172:173], v11 offset:40960
ds_read_b64_tr_b16 v[174:175], v11 offset:41984
s_waitcnt lgkmcnt(6)
v_mfma_f32_32x32x16_bf16 v[224:239], v[184:187], v[180:183], v[224:239]
ds_read_b128 v[164:167], v8 offset:19328
s_mov_b32 s36, 409600
buffer_load_dwordx4 v[44:47], v4, s[16:19], s36 offen
v_mfma_f32_32x32x16_bf16 v[240:255], v[188:191], v[180:183], v[240:255]
ds_write_b128 v5, v[128:131] offset:20480
s_waitcnt lgkmcnt(4)
v_mfma_f32_32x32x16_bf16 v[192:207], v[168:171], v[160:163], v[192:207]
ds_read_b128 v[176:179], v8 offset:2464
ds_read_b64_tr_b16 v[184:185], v10 offset:45056
ds_read_b64_tr_b16 v[186:187], v10 offset:46080
s_waitcnt lgkmcnt(5)
v_mfma_f32_32x32x16_bf16 v[208:223], v[172:175], v[160:163], v[208:223]
ds_read_b64_tr_b16 v[188:189], v11 offset:45056
ds_read_b64_tr_b16 v[190:191], v11 offset:46080
s_waitcnt lgkmcnt(6)
v_mfma_f32_32x32x16_bf16 v[224:239], v[168:171], v[164:167], v[224:239]
ds_read_b128 v[180:183], v8 offset:19360
s_mov_b32 s36, 425984
buffer_load_dwordx4 v[48:51], v4, s[16:19], s36 offen
v_mfma_f32_32x32x16_bf16 v[240:255], v[172:175], v[164:167], v[240:255]
ds_write_b128 v5, v[132:135] offset:24576
s_waitcnt lgkmcnt(4)
v_mfma_f32_32x32x16_bf16 v[192:207], v[184:187], v[176:179], v[192:207]
ds_read_b128 v[160:163], v8 offset:2496
ds_read_b64_tr_b16 v[168:169], v10 offset:0
ds_read_b64_tr_b16 v[170:171], v10 offset:1024
s_waitcnt lgkmcnt(5)
v_mfma_f32_32x32x16_bf16 v[208:223], v[188:191], v[176:179], v[208:223]
ds_read_b64_tr_b16 v[172:173], v11 offset:0
ds_read_b64_tr_b16 v[174:175], v11 offset:1024
s_waitcnt lgkmcnt(6)
v_mfma_f32_32x32x16_bf16 v[224:239], v[184:187], v[180:183], v[224:239]
ds_read_b128 v[164:167], v8 offset:19392
s_mov_b32 s36, 442368
buffer_load_dwordx4 v[52:55], v4, s[16:19], s36 offen
v_mfma_f32_32x32x16_bf16 v[240:255], v[188:191], v[180:183], v[240:255]
ds_write_b128 v5, v[136:139] offset:28672
s_barrier
s_waitcnt lgkmcnt(4)
v_mfma_f32_32x32x16_bf16 v[192:207], v[168:171], v[160:163], v[192:207]
ds_read_b128 v[176:179], v8 offset:2528
ds_read_b64_tr_b16 v[184:185], v10 offset:4096
ds_read_b64_tr_b16 v[186:187], v10 offset:5120
s_waitcnt lgkmcnt(5)
v_mfma_f32_32x32x16_bf16 v[208:223], v[172:175], v[160:163], v[208:223]
ds_read_b64_tr_b16 v[188:189], v11 offset:4096
ds_read_b64_tr_b16 v[190:191], v11 offset:5120
s_waitcnt lgkmcnt(6)
v_mfma_f32_32x32x16_bf16 v[224:239], v[168:171], v[164:167], v[224:239]
ds_read_b128 v[180:183], v8 offset:19424
s_mov_b32 s36, 458752
buffer_load_dwordx4 v[24:27], v4, s[16:19], s36 offen
v_mfma_f32_32x32x16_bf16 v[240:255], v[172:175], v[164:167], v[240:255]
s_waitcnt vmcnt(4)
ds_write_b128 v5, v[140:143] offset:32768
s_waitcnt lgkmcnt(4)
v_mfma_f32_32x32x16_bf16 v[192:207], v[184:187], v[176:179], v[192:207]
ds_read_b128 v[160:163], v8 offset:2560
ds_read_b64_tr_b16 v[168:169], v10 offset:8192
ds_read_b64_tr_b16 v[170:171], v10 offset:9216
s_waitcnt lgkmcnt(5)
v_mfma_f32_32x32x16_bf16 v[208:223], v[188:191], v[176:179], v[208:223]
ds_read_b64_tr_b16 v[172:173], v11 offset:8192
ds_read_b64_tr_b16 v[174:175], v11 offset:9216
s_waitcnt lgkmcnt(6)
v_mfma_f32_32x32x16_bf16 v[224:239], v[184:187], v[180:183], v[224:239]
ds_read_b128 v[164:167], v8 offset:19456
s_mov_b32 s36, 475136
buffer_load_dwordx4 v[28:31], v4, s[16:19], s36 offen
v_mfma_f32_32x32x16_bf16 v[240:255], v[188:191], v[180:183], v[240:255]
ds_write_b128 v5, v[144:147] offset:36864
s_waitcnt lgkmcnt(4)
v_mfma_f32_32x32x16_bf16 v[192:207], v[168:171], v[160:163], v[192:207]
ds_read_b128 v[176:179], v8 offset:2592
ds_read_b64_tr_b16 v[184:185], v10 offset:12288
ds_read_b64_tr_b16 v[186:187], v10 offset:13312
s_waitcnt lgkmcnt(5)
v_mfma_f32_32x32x16_bf16 v[208:223], v[172:175], v[160:163], v[208:223]
ds_read_b64_tr_b16 v[188:189], v11 offset:12288
ds_read_b64_tr_b16 v[190:191], v11 offset:13312
s_waitcnt lgkmcnt(6)
v_mfma_f32_32x32x16_bf16 v[224:239], v[168:171], v[164:167], v[224:239]
ds_read_b128 v[180:183], v8 offset:19488
s_mov_b32 s36, 491520
buffer_load_dwordx4 v[32:35], v4, s[16:19], s36 offen
v_mfma_f32_32x32x16_bf16 v[240:255], v[172:175], v[164:167], v[240:255]
ds_write_b128 v5, v[148:151] offset:40960
s_waitcnt lgkmcnt(4)
v_mfma_f32_32x32x16_bf16 v[192:207], v[184:187], v[176:179], v[192:207]
ds_read_b128 v[160:163], v8 offset:1056
ds_read_b64_tr_b16 v[168:169], v10 offset:16384
ds_read_b64_tr_b16 v[170:171], v10 offset:17408
s_waitcnt lgkmcnt(5)
v_mfma_f32_32x32x16_bf16 v[208:223], v[188:191], v[176:179], v[208:223]
ds_read_b64_tr_b16 v[172:173], v11 offset:16384
ds_read_b64_tr_b16 v[174:175], v11 offset:17408
s_waitcnt lgkmcnt(6)
v_mfma_f32_32x32x16_bf16 v[224:239], v[184:187], v[180:183], v[224:239]
ds_read_b128 v[164:167], v8 offset:17952
s_mov_b32 s36, 507904
buffer_load_dwordx4 v[36:39], v4, s[16:19], s36 offen
v_mfma_f32_32x32x16_bf16 v[240:255], v[188:191], v[180:183], v[240:255]
ds_write_b128 v5, v[152:155] offset:45056
s_barrier
s_waitcnt lgkmcnt(4)
v_mfma_f32_32x32x16_bf16 v[192:207], v[168:171], v[160:163], v[192:207]
ds_read_b128 v[176:179], v8 offset:1088
ds_read_b64_tr_b16 v[184:185], v10 offset:20480
ds_read_b64_tr_b16 v[186:187], v10 offset:21504
s_waitcnt lgkmcnt(5)
v_mfma_f32_32x32x16_bf16 v[208:223], v[172:175], v[160:163], v[208:223]
ds_read_b64_tr_b16 v[188:189], v11 offset:20480
ds_read_b64_tr_b16 v[190:191], v11 offset:21504
s_waitcnt lgkmcnt(6)
v_mfma_f32_32x32x16_bf16 v[224:239], v[168:171], v[164:167], v[224:239]
ds_read_b128 v[180:183], v8 offset:17984
s_mov_b32 s36, 524288
buffer_load_dwordx4 v[124:127], v4, s[16:19], s36 offen
v_mfma_f32_32x32x16_bf16 v[240:255], v[172:175], v[164:167], v[240:255]
s_waitcnt vmcnt(4)
ds_write_b128 v5, v[40:43] offset:0
s_waitcnt lgkmcnt(4)
v_mfma_f32_32x32x16_bf16 v[192:207], v[184:187], v[176:179], v[192:207]
ds_read_b128 v[160:163], v8 offset:1120
ds_read_b64_tr_b16 v[168:169], v10 offset:24576
ds_read_b64_tr_b16 v[170:171], v10 offset:25600
s_waitcnt lgkmcnt(5)
v_mfma_f32_32x32x16_bf16 v[208:223], v[188:191], v[176:179], v[208:223]
ds_read_b64_tr_b16 v[172:173], v11 offset:24576
ds_read_b64_tr_b16 v[174:175], v11 offset:25600
s_waitcnt lgkmcnt(6)
v_mfma_f32_32x32x16_bf16 v[224:239], v[184:187], v[180:183], v[224:239]
ds_read_b128 v[164:167], v8 offset:18016
s_mov_b32 s36, 540672
buffer_load_dwordx4 v[128:131], v4, s[16:19], s36 offen
v_mfma_f32_32x32x16_bf16 v[240:255], v[188:191], v[180:183], v[240:255]
ds_write_b128 v5, v[44:47] offset:4096
s_waitcnt lgkmcnt(4)
v_mfma_f32_32x32x16_bf16 v[192:207], v[168:171], v[160:163], v[192:207]
ds_read_b128 v[176:179], v8 offset:1152
ds_read_b64_tr_b16 v[184:185], v10 offset:28672
ds_read_b64_tr_b16 v[186:187], v10 offset:29696
s_waitcnt lgkmcnt(5)
v_mfma_f32_32x32x16_bf16 v[208:223], v[172:175], v[160:163], v[208:223]
ds_read_b64_tr_b16 v[188:189], v11 offset:28672
ds_read_b64_tr_b16 v[190:191], v11 offset:29696
s_waitcnt lgkmcnt(6)
v_mfma_f32_32x32x16_bf16 v[224:239], v[168:171], v[164:167], v[224:239]
ds_read_b128 v[180:183], v8 offset:18048
s_mov_b32 s36, 557056
buffer_load_dwordx4 v[132:135], v4, s[16:19], s36 offen
v_mfma_f32_32x32x16_bf16 v[240:255], v[172:175], v[164:167], v[240:255]
ds_write_b128 v5, v[48:51] offset:8192
s_waitcnt lgkmcnt(4)
v_mfma_f32_32x32x16_bf16 v[192:207], v[184:187], v[176:179], v[192:207]
ds_read_b128 v[160:163], v8 offset:1184
ds_read_b64_tr_b16 v[168:169], v10 offset:32768
ds_read_b64_tr_b16 v[170:171], v10 offset:33792
s_waitcnt lgkmcnt(5)
v_mfma_f32_32x32x16_bf16 v[208:223], v[188:191], v[176:179], v[208:223]
ds_read_b64_tr_b16 v[172:173], v11 offset:32768
ds_read_b64_tr_b16 v[174:175], v11 offset:33792
s_waitcnt lgkmcnt(6)
v_mfma_f32_32x32x16_bf16 v[224:239], v[184:187], v[180:183], v[224:239]
ds_read_b128 v[164:167], v8 offset:18080
s_mov_b32 s36, 573440
buffer_load_dwordx4 v[136:139], v4, s[16:19], s36 offen
v_mfma_f32_32x32x16_bf16 v[240:255], v[188:191], v[180:183], v[240:255]
ds_write_b128 v5, v[52:55] offset:12288
s_barrier
s_waitcnt lgkmcnt(4)
v_mfma_f32_32x32x16_bf16 v[192:207], v[168:171], v[160:163], v[192:207]
ds_read_b128 v[176:179], v8 offset:1216
ds_read_b64_tr_b16 v[184:185], v10 offset:36864
ds_read_b64_tr_b16 v[186:187], v10 offset:37888
s_waitcnt lgkmcnt(5)
v_mfma_f32_32x32x16_bf16 v[208:223], v[172:175], v[160:163], v[208:223]
ds_read_b64_tr_b16 v[188:189], v11 offset:36864
ds_read_b64_tr_b16 v[190:191], v11 offset:37888
s_waitcnt lgkmcnt(6)
v_mfma_f32_32x32x16_bf16 v[224:239], v[168:171], v[164:167], v[224:239]
ds_read_b128 v[180:183], v8 offset:18112
s_mov_b32 s36, 589824
buffer_load_dwordx4 v[140:143], v4, s[16:19], s36 offen
v_mfma_f32_32x32x16_bf16 v[240:255], v[172:175], v[164:167], v[240:255]
s_waitcnt vmcnt(4)
ds_write_b128 v5, v[24:27] offset:16384
s_waitcnt lgkmcnt(4)
v_mfma_f32_32x32x16_bf16 v[192:207], v[184:187], v[176:179], v[192:207]
ds_read_b128 v[160:163], v8 offset:1248
ds_read_b64_tr_b16 v[168:169], v10 offset:40960
ds_read_b64_tr_b16 v[170:171], v10 offset:41984
s_waitcnt lgkmcnt(5)
v_mfma_f32_32x32x16_bf16 v[208:223], v[188:191], v[176:179], v[208:223]
ds_read_b64_tr_b16 v[172:173], v11 offset:40960
ds_read_b64_tr_b16 v[174:175], v11 offset:41984
s_waitcnt lgkmcnt(6)
v_mfma_f32_32x32x16_bf16 v[224:239], v[184:187], v[180:183], v[224:239]
ds_read_b128 v[164:167], v8 offset:18144
s_mov_b32 s36, 606208
buffer_load_dwordx4 v[144:147], v4, s[16:19], s36 offen
v_mfma_f32_32x32x16_bf16 v[240:255], v[188:191], v[180:183], v[240:255]
ds_write_b128 v5, v[28:31] offset:20480
s_waitcnt lgkmcnt(4)
v_mfma_f32_32x32x16_bf16 v[192:207], v[168:171], v[160:163], v[192:207]
ds_read_b128 v[176:179], v8 offset:1280
ds_read_b64_tr_b16 v[184:185], v10 offset:45056
ds_read_b64_tr_b16 v[186:187], v10 offset:46080
s_waitcnt lgkmcnt(5)
v_mfma_f32_32x32x16_bf16 v[208:223], v[172:175], v[160:163], v[208:223]
ds_read_b64_tr_b16 v[188:189], v11 offset:45056
ds_read_b64_tr_b16 v[190:191], v11 offset:46080
s_waitcnt lgkmcnt(6)
v_mfma_f32_32x32x16_bf16 v[224:239], v[168:171], v[164:167], v[224:239]
ds_read_b128 v[180:183], v8 offset:18176
s_mov_b32 s36, 622592
buffer_load_dwordx4 v[148:151], v4, s[16:19], s36 offen
v_mfma_f32_32x32x16_bf16 v[240:255], v[172:175], v[164:167], v[240:255]
ds_write_b128 v5, v[32:35] offset:24576
s_waitcnt lgkmcnt(4)
v_mfma_f32_32x32x16_bf16 v[192:207], v[184:187], v[176:179], v[192:207]
ds_read_b128 v[160:163], v8 offset:1312
ds_read_b64_tr_b16 v[168:169], v10 offset:0
ds_read_b64_tr_b16 v[170:171], v10 offset:1024
s_waitcnt lgkmcnt(5)
v_mfma_f32_32x32x16_bf16 v[208:223], v[188:191], v[176:179], v[208:223]
ds_read_b64_tr_b16 v[172:173], v11 offset:0
ds_read_b64_tr_b16 v[174:175], v11 offset:1024
s_waitcnt lgkmcnt(6)
v_mfma_f32_32x32x16_bf16 v[224:239], v[184:187], v[180:183], v[224:239]
ds_read_b128 v[164:167], v8 offset:18208
s_mov_b32 s36, 638976
buffer_load_dwordx4 v[152:155], v4, s[16:19], s36 offen
v_mfma_f32_32x32x16_bf16 v[240:255], v[188:191], v[180:183], v[240:255]
ds_write_b128 v5, v[36:39] offset:28672
s_barrier
s_waitcnt lgkmcnt(4)
v_mfma_f32_32x32x16_bf16 v[192:207], v[168:171], v[160:163], v[192:207]
ds_read_b128 v[176:179], v8 offset:1344
ds_read_b64_tr_b16 v[184:185], v10 offset:4096
ds_read_b64_tr_b16 v[186:187], v10 offset:5120
s_waitcnt lgkmcnt(5)
v_mfma_f32_32x32x16_bf16 v[208:223], v[172:175], v[160:163], v[208:223]
ds_read_b64_tr_b16 v[188:189], v11 offset:4096
ds_read_b64_tr_b16 v[190:191], v11 offset:5120
s_waitcnt lgkmcnt(6)
v_mfma_f32_32x32x16_bf16 v[224:239], v[168:171], v[164:167], v[224:239]
ds_read_b128 v[180:183], v8 offset:18240
s_mov_b32 s36, 655360
buffer_load_dwordx4 v[40:43], v4, s[16:19], s36 offen
v_mfma_f32_32x32x16_bf16 v[240:255], v[172:175], v[164:167], v[240:255]
s_waitcnt vmcnt(4)
ds_write_b128 v5, v[124:127] offset:32768
s_waitcnt lgkmcnt(4)
v_mfma_f32_32x32x16_bf16 v[192:207], v[184:187], v[176:179], v[192:207]
ds_read_b128 v[160:163], v8 offset:1376
ds_read_b64_tr_b16 v[168:169], v10 offset:8192
ds_read_b64_tr_b16 v[170:171], v10 offset:9216
s_waitcnt lgkmcnt(5)
v_mfma_f32_32x32x16_bf16 v[208:223], v[188:191], v[176:179], v[208:223]
ds_read_b64_tr_b16 v[172:173], v11 offset:8192
ds_read_b64_tr_b16 v[174:175], v11 offset:9216
s_waitcnt lgkmcnt(6)
v_mfma_f32_32x32x16_bf16 v[224:239], v[184:187], v[180:183], v[224:239]
ds_read_b128 v[164:167], v8 offset:18272
s_mov_b32 s36, 671744
buffer_load_dwordx4 v[44:47], v4, s[16:19], s36 offen
v_mfma_f32_32x32x16_bf16 v[240:255], v[188:191], v[180:183], v[240:255]
ds_write_b128 v5, v[128:131] offset:36864
s_waitcnt lgkmcnt(4)
v_mfma_f32_32x32x16_bf16 v[192:207], v[168:171], v[160:163], v[192:207]
ds_read_b128 v[176:179], v8 offset:1408
ds_read_b64_tr_b16 v[184:185], v10 offset:12288
ds_read_b64_tr_b16 v[186:187], v10 offset:13312
s_waitcnt lgkmcnt(5)
v_mfma_f32_32x32x16_bf16 v[208:223], v[172:175], v[160:163], v[208:223]
ds_read_b64_tr_b16 v[188:189], v11 offset:12288
ds_read_b64_tr_b16 v[190:191], v11 offset:13312
s_waitcnt lgkmcnt(6)
v_mfma_f32_32x32x16_bf16 v[224:239], v[168:171], v[164:167], v[224:239]
ds_read_b128 v[180:183], v8 offset:18304
s_mov_b32 s36, 688128
buffer_load_dwordx4 v[48:51], v4, s[16:19], s36 offen
v_mfma_f32_32x32x16_bf16 v[240:255], v[172:175], v[164:167], v[240:255]
ds_write_b128 v5, v[132:135] offset:40960
s_waitcnt lgkmcnt(4)
v_mfma_f32_32x32x16_bf16 v[192:207], v[184:187], v[176:179], v[192:207]
ds_read_b128 v[160:163], v8 offset:1440
ds_read_b64_tr_b16 v[168:169], v10 offset:16384
ds_read_b64_tr_b16 v[170:171], v10 offset:17408
s_waitcnt lgkmcnt(5)
v_mfma_f32_32x32x16_bf16 v[208:223], v[188:191], v[176:179], v[208:223]
ds_read_b64_tr_b16 v[172:173], v11 offset:16384
ds_read_b64_tr_b16 v[174:175], v11 offset:17408
s_waitcnt lgkmcnt(6)
v_mfma_f32_32x32x16_bf16 v[224:239], v[184:187], v[180:183], v[224:239]
ds_read_b128 v[164:167], v8 offset:18336
s_mov_b32 s36, 704512
buffer_load_dwordx4 v[52:55], v4, s[16:19], s36 offen
v_mfma_f32_32x32x16_bf16 v[240:255], v[188:191], v[180:183], v[240:255]
ds_write_b128 v5, v[136:139] offset:45056
s_barrier
s_waitcnt lgkmcnt(4)
v_mfma_f32_32x32x16_bf16 v[192:207], v[168:171], v[160:163], v[192:207]
ds_read_b128 v[176:179], v8 offset:1472
ds_read_b64_tr_b16 v[184:185], v10 offset:20480
ds_read_b64_tr_b16 v[186:187], v10 offset:21504
s_waitcnt lgkmcnt(5)
v_mfma_f32_32x32x16_bf16 v[208:223], v[172:175], v[160:163], v[208:223]
ds_read_b64_tr_b16 v[188:189], v11 offset:20480
ds_read_b64_tr_b16 v[190:191], v11 offset:21504
s_waitcnt lgkmcnt(6)
v_mfma_f32_32x32x16_bf16 v[224:239], v[168:171], v[164:167], v[224:239]
ds_read_b128 v[180:183], v8 offset:18368
s_mov_b32 s36, 720896
buffer_load_dwordx4 v[24:27], v4, s[16:19], s36 offen
v_mfma_f32_32x32x16_bf16 v[240:255], v[172:175], v[164:167], v[240:255]
s_waitcnt vmcnt(4)
ds_write_b128 v5, v[140:143] offset:0
s_waitcnt lgkmcnt(4)
v_mfma_f32_32x32x16_bf16 v[192:207], v[184:187], v[176:179], v[192:207]
ds_read_b128 v[160:163], v8 offset:1504
ds_read_b64_tr_b16 v[168:169], v10 offset:24576
ds_read_b64_tr_b16 v[170:171], v10 offset:25600
s_waitcnt lgkmcnt(5)
v_mfma_f32_32x32x16_bf16 v[208:223], v[188:191], v[176:179], v[208:223]
ds_read_b64_tr_b16 v[172:173], v11 offset:24576
ds_read_b64_tr_b16 v[174:175], v11 offset:25600
s_waitcnt lgkmcnt(6)
v_mfma_f32_32x32x16_bf16 v[224:239], v[184:187], v[180:183], v[224:239]
ds_read_b128 v[164:167], v8 offset:18400
s_mov_b32 s36, 737280
buffer_load_dwordx4 v[28:31], v4, s[16:19], s36 offen
v_mfma_f32_32x32x16_bf16 v[240:255], v[188:191], v[180:183], v[240:255]
ds_write_b128 v5, v[144:147] offset:4096
s_waitcnt lgkmcnt(4)
v_mfma_f32_32x32x16_bf16 v[192:207], v[168:171], v[160:163], v[192:207]
ds_read_b128 v[176:179], v8 offset:1536
ds_read_b64_tr_b16 v[184:185], v10 offset:28672
ds_read_b64_tr_b16 v[186:187], v10 offset:29696
s_waitcnt lgkmcnt(5)
v_mfma_f32_32x32x16_bf16 v[208:223], v[172:175], v[160:163], v[208:223]
ds_read_b64_tr_b16 v[188:189], v11 offset:28672
ds_read_b64_tr_b16 v[190:191], v11 offset:29696
s_waitcnt lgkmcnt(6)
v_mfma_f32_32x32x16_bf16 v[224:239], v[168:171], v[164:167], v[224:239]
ds_read_b128 v[180:183], v8 offset:18432
s_mov_b32 s36, 753664
buffer_load_dwordx4 v[32:35], v4, s[16:19], s36 offen
v_mfma_f32_32x32x16_bf16 v[240:255], v[172:175], v[164:167], v[240:255]
ds_write_b128 v5, v[148:151] offset:8192
s_waitcnt lgkmcnt(4)
v_mfma_f32_32x32x16_bf16 v[192:207], v[184:187], v[176:179], v[192:207]
ds_read_b128 v[160:163], v8 offset:0
ds_read_b64_tr_b16 v[168:169], v10 offset:32768
ds_read_b64_tr_b16 v[170:171], v10 offset:33792
s_waitcnt lgkmcnt(5)
v_mfma_f32_32x32x16_bf16 v[208:223], v[188:191], v[176:179], v[208:223]
ds_read_b64_tr_b16 v[172:173], v11 offset:32768
ds_read_b64_tr_b16 v[174:175], v11 offset:33792
s_waitcnt lgkmcnt(6)
v_mfma_f32_32x32x16_bf16 v[224:239], v[184:187], v[180:183], v[224:239]
ds_read_b128 v[164:167], v8 offset:16896
s_mov_b32 s36, 770048
buffer_load_dwordx4 v[36:39], v4, s[16:19], s36 offen
v_mfma_f32_32x32x16_bf16 v[240:255], v[188:191], v[180:183], v[240:255]
ds_write_b128 v5, v[152:155] offset:12288
s_barrier
s_waitcnt lgkmcnt(4)
v_mfma_f32_32x32x16_bf16 v[192:207], v[168:171], v[160:163], v[192:207]
ds_read_b128 v[176:179], v8 offset:32
ds_read_b64_tr_b16 v[184:185], v10 offset:36864
ds_read_b64_tr_b16 v[186:187], v10 offset:37888
s_waitcnt lgkmcnt(5)
v_mfma_f32_32x32x16_bf16 v[208:223], v[172:175], v[160:163], v[208:223]
ds_read_b64_tr_b16 v[188:189], v11 offset:36864
ds_read_b64_tr_b16 v[190:191], v11 offset:37888
s_waitcnt lgkmcnt(6)
v_mfma_f32_32x32x16_bf16 v[224:239], v[168:171], v[164:167], v[224:239]
ds_read_b128 v[180:183], v8 offset:16928
v_mfma_f32_32x32x16_bf16 v[240:255], v[172:175], v[164:167], v[240:255]
s_waitcnt vmcnt(4)
ds_write_b128 v5, v[40:43] offset:16384
s_waitcnt lgkmcnt(4)
v_mfma_f32_32x32x16_bf16 v[192:207], v[184:187], v[176:179], v[192:207]
ds_read_b128 v[160:163], v8 offset:64
ds_read_b64_tr_b16 v[168:169], v10 offset:40960
ds_read_b64_tr_b16 v[170:171], v10 offset:41984
s_waitcnt lgkmcnt(5)
v_mfma_f32_32x32x16_bf16 v[208:223], v[188:191], v[176:179], v[208:223]
ds_read_b64_tr_b16 v[172:173], v11 offset:40960
ds_read_b64_tr_b16 v[174:175], v11 offset:41984
s_waitcnt lgkmcnt(6)
v_mfma_f32_32x32x16_bf16 v[224:239], v[184:187], v[180:183], v[224:239]
ds_read_b128 v[164:167], v8 offset:16960
v_mfma_f32_32x32x16_bf16 v[240:255], v[188:191], v[180:183], v[240:255]
ds_write_b128 v5, v[44:47] offset:20480
s_waitcnt lgkmcnt(4)
v_mfma_f32_32x32x16_bf16 v[192:207], v[168:171], v[160:163], v[192:207]
ds_read_b128 v[176:179], v8 offset:96
ds_read_b64_tr_b16 v[184:185], v10 offset:45056
ds_read_b64_tr_b16 v[186:187], v10 offset:46080
s_waitcnt lgkmcnt(5)
v_mfma_f32_32x32x16_bf16 v[208:223], v[172:175], v[160:163], v[208:223]
ds_read_b64_tr_b16 v[188:189], v11 offset:45056
ds_read_b64_tr_b16 v[190:191], v11 offset:46080
s_waitcnt lgkmcnt(6)
v_mfma_f32_32x32x16_bf16 v[224:239], v[168:171], v[164:167], v[224:239]
ds_read_b128 v[180:183], v8 offset:16992
v_mfma_f32_32x32x16_bf16 v[240:255], v[172:175], v[164:167], v[240:255]
ds_write_b128 v5, v[48:51] offset:24576
s_waitcnt lgkmcnt(4)
v_mfma_f32_32x32x16_bf16 v[192:207], v[184:187], v[176:179], v[192:207]
ds_read_b128 v[160:163], v8 offset:128
ds_read_b64_tr_b16 v[168:169], v10 offset:0
ds_read_b64_tr_b16 v[170:171], v10 offset:1024
s_waitcnt lgkmcnt(5)
v_mfma_f32_32x32x16_bf16 v[208:223], v[188:191], v[176:179], v[208:223]
ds_read_b64_tr_b16 v[172:173], v11 offset:0
ds_read_b64_tr_b16 v[174:175], v11 offset:1024
s_waitcnt lgkmcnt(6)
v_mfma_f32_32x32x16_bf16 v[224:239], v[184:187], v[180:183], v[224:239]
ds_read_b128 v[164:167], v8 offset:17024
v_mfma_f32_32x32x16_bf16 v[240:255], v[188:191], v[180:183], v[240:255]
ds_write_b128 v5, v[52:55] offset:28672
s_barrier
s_waitcnt lgkmcnt(4)
v_mfma_f32_32x32x16_bf16 v[192:207], v[168:171], v[160:163], v[192:207]
ds_read_b128 v[176:179], v8 offset:160
ds_read_b64_tr_b16 v[184:185], v10 offset:4096
ds_read_b64_tr_b16 v[186:187], v10 offset:5120
s_waitcnt lgkmcnt(5)
v_mfma_f32_32x32x16_bf16 v[208:223], v[172:175], v[160:163], v[208:223]
ds_read_b64_tr_b16 v[188:189], v11 offset:4096
ds_read_b64_tr_b16 v[190:191], v11 offset:5120
s_waitcnt lgkmcnt(6)
v_mfma_f32_32x32x16_bf16 v[224:239], v[168:171], v[164:167], v[224:239]
ds_read_b128 v[180:183], v8 offset:17056
v_mfma_f32_32x32x16_bf16 v[240:255], v[172:175], v[164:167], v[240:255]
s_waitcnt vmcnt(0)
ds_write_b128 v5, v[24:27] offset:32768
s_waitcnt lgkmcnt(4)
v_mfma_f32_32x32x16_bf16 v[192:207], v[184:187], v[176:179], v[192:207]
ds_read_b128 v[160:163], v8 offset:192
ds_read_b64_tr_b16 v[168:169], v10 offset:8192
ds_read_b64_tr_b16 v[170:171], v10 offset:9216
s_waitcnt lgkmcnt(5)
v_mfma_f32_32x32x16_bf16 v[208:223], v[188:191], v[176:179], v[208:223]
ds_read_b64_tr_b16 v[172:173], v11 offset:8192
ds_read_b64_tr_b16 v[174:175], v11 offset:9216
s_waitcnt lgkmcnt(6)
v_mfma_f32_32x32x16_bf16 v[224:239], v[184:187], v[180:183], v[224:239]
ds_read_b128 v[164:167], v8 offset:17088
v_mfma_f32_32x32x16_bf16 v[240:255], v[188:191], v[180:183], v[240:255]
ds_write_b128 v5, v[28:31] offset:36864
s_waitcnt lgkmcnt(4)
v_mfma_f32_32x32x16_bf16 v[192:207], v[168:171], v[160:163], v[192:207]
ds_read_b128 v[176:179], v8 offset:224
ds_read_b64_tr_b16 v[184:185], v10 offset:12288
ds_read_b64_tr_b16 v[186:187], v10 offset:13312
s_waitcnt lgkmcnt(5)
v_mfma_f32_32x32x16_bf16 v[208:223], v[172:175], v[160:163], v[208:223]
ds_read_b64_tr_b16 v[188:189], v11 offset:12288
ds_read_b64_tr_b16 v[190:191], v11 offset:13312
s_waitcnt lgkmcnt(6)
v_mfma_f32_32x32x16_bf16 v[224:239], v[168:171], v[164:167], v[224:239]
ds_read_b128 v[180:183], v8 offset:17120
v_mfma_f32_32x32x16_bf16 v[240:255], v[172:175], v[164:167], v[240:255]
ds_write_b128 v5, v[32:35] offset:40960
s_waitcnt lgkmcnt(4)
v_mfma_f32_32x32x16_bf16 v[192:207], v[184:187], v[176:179], v[192:207]
ds_read_b128 v[160:163], v8 offset:256
ds_read_b64_tr_b16 v[168:169], v10 offset:16384
ds_read_b64_tr_b16 v[170:171], v10 offset:17408
s_waitcnt lgkmcnt(5)
v_mfma_f32_32x32x16_bf16 v[208:223], v[188:191], v[176:179], v[208:223]
ds_read_b64_tr_b16 v[172:173], v11 offset:16384
ds_read_b64_tr_b16 v[174:175], v11 offset:17408
s_waitcnt lgkmcnt(6)
v_mfma_f32_32x32x16_bf16 v[224:239], v[184:187], v[180:183], v[224:239]
ds_read_b128 v[164:167], v8 offset:17152
v_mfma_f32_32x32x16_bf16 v[240:255], v[188:191], v[180:183], v[240:255]
ds_write_b128 v5, v[36:39] offset:45056
s_barrier
s_waitcnt lgkmcnt(4)
v_mfma_f32_32x32x16_bf16 v[192:207], v[168:171], v[160:163], v[192:207]
ds_read_b128 v[176:179], v8 offset:288
ds_read_b64_tr_b16 v[184:185], v10 offset:20480
ds_read_b64_tr_b16 v[186:187], v10 offset:21504
s_waitcnt lgkmcnt(5)
v_mfma_f32_32x32x16_bf16 v[208:223], v[172:175], v[160:163], v[208:223]
ds_read_b64_tr_b16 v[188:189], v11 offset:20480
ds_read_b64_tr_b16 v[190:191], v11 offset:21504
s_waitcnt lgkmcnt(6)
v_mfma_f32_32x32x16_bf16 v[224:239], v[168:171], v[164:167], v[224:239]
ds_read_b128 v[180:183], v8 offset:17184
v_mfma_f32_32x32x16_bf16 v[240:255], v[172:175], v[164:167], v[240:255]
s_waitcnt lgkmcnt(3)
v_mfma_f32_32x32x16_bf16 v[192:207], v[184:187], v[176:179], v[192:207]
ds_read_b128 v[160:163], v8 offset:320
ds_read_b64_tr_b16 v[168:169], v10 offset:24576
ds_read_b64_tr_b16 v[170:171], v10 offset:25600
s_waitcnt lgkmcnt(4)
v_mfma_f32_32x32x16_bf16 v[208:223], v[188:191], v[176:179], v[208:223]
ds_read_b64_tr_b16 v[172:173], v11 offset:24576
ds_read_b64_tr_b16 v[174:175], v11 offset:25600
s_waitcnt lgkmcnt(5)
v_mfma_f32_32x32x16_bf16 v[224:239], v[184:187], v[180:183], v[224:239]
ds_read_b128 v[164:167], v8 offset:17216
v_mfma_f32_32x32x16_bf16 v[240:255], v[188:191], v[180:183], v[240:255]
s_waitcnt lgkmcnt(3)
v_mfma_f32_32x32x16_bf16 v[192:207], v[168:171], v[160:163], v[192:207]
ds_read_b128 v[176:179], v8 offset:352
ds_read_b64_tr_b16 v[184:185], v10 offset:28672
ds_read_b64_tr_b16 v[186:187], v10 offset:29696
s_waitcnt lgkmcnt(4)
v_mfma_f32_32x32x16_bf16 v[208:223], v[172:175], v[160:163], v[208:223]
ds_read_b64_tr_b16 v[188:189], v11 offset:28672
ds_read_b64_tr_b16 v[190:191], v11 offset:29696
s_waitcnt lgkmcnt(5)
v_mfma_f32_32x32x16_bf16 v[224:239], v[168:171], v[164:167], v[224:239]
ds_read_b128 v[180:183], v8 offset:17248
v_mfma_f32_32x32x16_bf16 v[240:255], v[172:175], v[164:167], v[240:255]
s_waitcnt lgkmcnt(3)
v_mfma_f32_32x32x16_bf16 v[192:207], v[184:187], v[176:179], v[192:207]
ds_read_b128 v[160:163], v8 offset:384
ds_read_b64_tr_b16 v[168:169], v10 offset:32768
ds_read_b64_tr_b16 v[170:171], v10 offset:33792
s_waitcnt lgkmcnt(4)
v_mfma_f32_32x32x16_bf16 v[208:223], v[188:191], v[176:179], v[208:223]
ds_read_b64_tr_b16 v[172:173], v11 offset:32768
ds_read_b64_tr_b16 v[174:175], v11 offset:33792
s_waitcnt lgkmcnt(5)
v_mfma_f32_32x32x16_bf16 v[224:239], v[184:187], v[180:183], v[224:239]
ds_read_b128 v[164:167], v8 offset:17280
v_mfma_f32_32x32x16_bf16 v[240:255], v[188:191], v[180:183], v[240:255]
s_barrier
s_waitcnt lgkmcnt(3)
v_mfma_f32_32x32x16_bf16 v[192:207], v[168:171], v[160:163], v[192:207]
ds_read_b128 v[176:179], v8 offset:416
ds_read_b64_tr_b16 v[184:185], v10 offset:36864
ds_read_b64_tr_b16 v[186:187], v10 offset:37888
s_waitcnt lgkmcnt(4)
v_mfma_f32_32x32x16_bf16 v[208:223], v[172:175], v[160:163], v[208:223]
ds_read_b64_tr_b16 v[188:189], v11 offset:36864
ds_read_b64_tr_b16 v[190:191], v11 offset:37888
s_waitcnt lgkmcnt(5)
v_mfma_f32_32x32x16_bf16 v[224:239], v[168:171], v[164:167], v[224:239]
ds_read_b128 v[180:183], v8 offset:17312
v_mfma_f32_32x32x16_bf16 v[240:255], v[172:175], v[164:167], v[240:255]
s_waitcnt lgkmcnt(3)
v_mfma_f32_32x32x16_bf16 v[192:207], v[184:187], v[176:179], v[192:207]
ds_read_b128 v[160:163], v8 offset:448
ds_read_b64_tr_b16 v[168:169], v10 offset:40960
ds_read_b64_tr_b16 v[170:171], v10 offset:41984
s_waitcnt lgkmcnt(4)
v_mfma_f32_32x32x16_bf16 v[208:223], v[188:191], v[176:179], v[208:223]
ds_read_b64_tr_b16 v[172:173], v11 offset:40960
ds_read_b64_tr_b16 v[174:175], v11 offset:41984
s_waitcnt lgkmcnt(5)
v_mfma_f32_32x32x16_bf16 v[224:239], v[184:187], v[180:183], v[224:239]
ds_read_b128 v[164:167], v8 offset:17344
v_mfma_f32_32x32x16_bf16 v[240:255], v[188:191], v[180:183], v[240:255]
s_waitcnt lgkmcnt(3)
v_mfma_f32_32x32x16_bf16 v[192:207], v[168:171], v[160:163], v[192:207]
ds_read_b128 v[176:179], v8 offset:480
ds_read_b64_tr_b16 v[184:185], v10 offset:45056
ds_read_b64_tr_b16 v[186:187], v10 offset:46080
s_waitcnt lgkmcnt(4)
v_mfma_f32_32x32x16_bf16 v[208:223], v[172:175], v[160:163], v[208:223]
ds_read_b64_tr_b16 v[188:189], v11 offset:45056
ds_read_b64_tr_b16 v[190:191], v11 offset:46080
s_waitcnt lgkmcnt(5)
v_mfma_f32_32x32x16_bf16 v[224:239], v[168:171], v[164:167], v[224:239]
ds_read_b128 v[180:183], v8 offset:17376
v_mfma_f32_32x32x16_bf16 v[240:255], v[172:175], v[164:167], v[240:255]
s_waitcnt lgkmcnt(3)
v_mfma_f32_32x32x16_bf16 v[192:207], v[184:187], v[176:179], v[192:207]
s_waitcnt lgkmcnt(1)
v_mfma_f32_32x32x16_bf16 v[208:223], v[188:191], v[176:179], v[208:223]
s_waitcnt lgkmcnt(0)
v_mfma_f32_32x32x16_bf16 v[224:239], v[184:187], v[180:183], v[224:239]
v_mfma_f32_32x32x16_bf16 v[240:255], v[188:191], v[180:183], v[240:255]
v_and_b32 v12, 31, v2
s_lshl_b32 s36, s29, 7
s_lshl_b32 s37, s32, 6
s_add_u32 s36, s36, s37
v_add_u32 v12, s36, v12
v_lshlrev_b32 v12, 9, v12
s_lshl_b32 s36, s27, 7
s_lshl_b32 s37, s33, 6
s_add_u32 s36, s36, s37
v_lshlrev_b32 v13, 3, v9
v_add_u32 v13, s36, v13
v_add_u32 v12, v12, v13
v_add_u32 v13, 0x4000, v12
s_mov_b32 s40, 0x4038aa3b
s_mov_b32 s41, 0xbfb8aa3b
s_mov_b32 s42, 0x41f00000
s_mov_b32 s43, 0x42700000
v_mul_f32 v160, s40, v192
v_mul_f32 v161, s40, v193
v_mul_f32 v162, s40, v194
v_mul_f32 v163, s40, v195
v_mul_f32 v168, s41, v208
v_mul_f32 v169, s41, v209
v_mul_f32 v170, s41, v210
v_mul_f32 v171, s41, v211
v_min_f32 v160, s42, v160
v_min_f32 v161, s42, v161
v_min_f32 v162, s42, v162
v_min_f32 v163, s42, v163
v_min_f32 v168, s43, v168
v_min_f32 v169, s43, v169
v_min_f32 v170, s43, v170
v_min_f32 v171, s43, v171
v_exp_f32 v160, v160
v_exp_f32 v161, v161
v_exp_f32 v162, v162
v_exp_f32 v163, v163
v_exp_f32 v168, v168
v_exp_f32 v169, v169
v_exp_f32 v170, v170
v_exp_f32 v171, v171
v_add_f32 v164, 1.0, v160
v_add_f32 v165, 1.0, v161
v_add_f32 v166, 1.0, v162
v_add_f32 v167, 1.0, v163
v_fma_f32 v168, v168, v164, v164
v_fma_f32 v169, v169, v165, v165
v_fma_f32 v170, v170, v166, v166
v_fma_f32 v171, v171, v167, v167
v_rcp_f32 v168, v168
v_rcp_f32 v169, v169
v_rcp_f32 v170, v170
v_rcp_f32 v171, v171
v_add_f32 v160, -1.0, v160
v_add_f32 v161, -1.0, v161
v_add_f32 v162, -1.0, v162
v_add_f32 v163, -1.0, v163
v_mul_f32 v160, v160, v168
v_mul_f32 v161, v161, v169
v_mul_f32 v162, v162, v170
v_mul_f32 v163, v163, v171
v_cvt_pk_bf16_f32 v176, v160, v161
v_cvt_pk_bf16_f32 v177, v162, v163
buffer_store_dwordx2 v[176:177], v12, s[20:23], 0 offen offset:0
v_mul_f32 v160, s40, v196
v_mul_f32 v161, s40, v197
v_mul_f32 v162, s40, v198
v_mul_f32 v163, s40, v199
v_mul_f32 v168, s41, v212
v_mul_f32 v169, s41, v213
v_mul_f32 v170, s41, v214
v_mul_f32 v171, s41, v215
v_min_f32 v160, s42, v160
v_min_f32 v161, s42, v161
v_min_f32 v162, s42, v162
v_min_f32 v163, s42, v163
v_min_f32 v168, s43, v168
v_min_f32 v169, s43, v169
v_min_f32 v170, s43, v170
v_min_f32 v171, s43, v171
v_exp_f32 v160, v160
v_exp_f32 v161, v161
v_exp_f32 v162, v162
v_exp_f32 v163, v163
v_exp_f32 v168, v168
v_exp_f32 v169, v169
v_exp_f32 v170, v170
v_exp_f32 v171, v171
v_add_f32 v164, 1.0, v160
v_add_f32 v165, 1.0, v161
v_add_f32 v166, 1.0, v162
v_add_f32 v167, 1.0, v163
v_fma_f32 v168, v168, v164, v164
v_fma_f32 v169, v169, v165, v165
v_fma_f32 v170, v170, v166, v166
v_fma_f32 v171, v171, v167, v167
v_rcp_f32 v168, v168
v_rcp_f32 v169, v169
v_rcp_f32 v170, v170
v_rcp_f32 v171, v171
v_add_f32 v160, -1.0, v160
v_add_f32 v161, -1.0, v161
v_add_f32 v162, -1.0, v162
v_add_f32 v163, -1.0, v163
v_mul_f32 v160, v160, v168
v_mul_f32 v161, v161, v169
v_mul_f32 v162, v162, v170
v_mul_f32 v163, v163, v171
v_cvt_pk_bf16_f32 v178, v160, v161
v_cvt_pk_bf16_f32 v179, v162, v163
buffer_store_dwordx2 v[178:179], v12, s[20:23], 0 offen offset:16
v_mul_f32 v160, s40, v200
v_mul_f32 v161, s40, v201
v_mul_f32 v162, s40, v202
v_mul_f32 v163, s40, v203
v_mul_f32 v168, s41, v216
v_mul_f32 v169, s41, v217
v_mul_f32 v170, s41, v218
v_mul_f32 v171, s41, v219
v_min_f32 v160, s42, v160
v_min_f32 v161, s42, v161
v_min_f32 v162, s42, v162
v_min_f32 v163, s42, v163
v_min_f32 v168, s43, v168
v_min_f32 v169, s43, v169
v_min_f32 v170, s43, v170
v_min_f32 v171, s43, v171
v_exp_f32 v160, v160
v_exp_f32 v161, v161
v_exp_f32 v162, v162
v_exp_f32 v163, v163
v_exp_f32 v168, v168
v_exp_f32 v169, v169
v_exp_f32 v170, v170
v_exp_f32 v171, v171
v_add_f32 v164, 1.0, v160
v_add_f32 v165, 1.0, v161
v_add_f32 v166, 1.0, v162
v_add_f32 v167, 1.0, v163
v_fma_f32 v168, v168, v164, v164
v_fma_f32 v169, v169, v165, v165
v_fma_f32 v170, v170, v166, v166
v_fma_f32 v171, v171, v167, v167
v_rcp_f32 v168, v168
v_rcp_f32 v169, v169
v_rcp_f32 v170, v170
v_rcp_f32 v171, v171
v_add_f32 v160, -1.0, v160
v_add_f32 v161, -1.0, v161
v_add_f32 v162, -1.0, v162
v_add_f32 v163, -1.0, v163
v_mul_f32 v160, v160, v168
v_mul_f32 v161, v161, v169
v_mul_f32 v162, v162, v170
v_mul_f32 v163, v163, v171
v_cvt_pk_bf16_f32 v180, v160, v161
v_cvt_pk_bf16_f32 v181, v162, v163
buffer_store_dwordx2 v[180:181], v12, s[20:23], 0 offen offset:32
v_mul_f32 v160, s40, v204
v_mul_f32 v161, s40, v205
v_mul_f32 v162, s40, v206
v_mul_f32 v163, s40, v207
v_mul_f32 v168, s41, v220
v_mul_f32 v169, s41, v221
v_mul_f32 v170, s41, v222
v_mul_f32 v171, s41, v223
v_min_f32 v160, s42, v160
v_min_f32 v161, s42, v161
v_min_f32 v162, s42, v162
v_min_f32 v163, s42, v163
v_min_f32 v168, s43, v168
v_min_f32 v169, s43, v169
v_min_f32 v170, s43, v170
v_min_f32 v171, s43, v171
v_exp_f32 v160, v160
v_exp_f32 v161, v161
v_exp_f32 v162, v162
v_exp_f32 v163, v163
v_exp_f32 v168, v168
v_exp_f32 v169, v169
v_exp_f32 v170, v170
v_exp_f32 v171, v171
v_add_f32 v164, 1.0, v160
v_add_f32 v165, 1.0, v161
v_add_f32 v166, 1.0, v162
v_add_f32 v167, 1.0, v163
v_fma_f32 v168, v168, v164, v164
v_fma_f32 v169, v169, v165, v165
v_fma_f32 v170, v170, v166, v166
v_fma_f32 v171, v171, v167, v167
v_rcp_f32 v168, v168
v_rcp_f32 v169, v169
v_rcp_f32 v170, v170
v_rcp_f32 v171, v171
v_add_f32 v160, -1.0, v160
v_add_f32 v161, -1.0, v161
v_add_f32 v162, -1.0, v162
v_add_f32 v163, -1.0, v163
v_mul_f32 v160, v160, v168
v_mul_f32 v161, v161, v169
v_mul_f32 v162, v162, v170
v_mul_f32 v163, v163, v171
v_cvt_pk_bf16_f32 v182, v160, v161
v_cvt_pk_bf16_f32 v183, v162, v163
buffer_store_dwordx2 v[182:183], v12, s[20:23], 0 offen offset:48
v_mul_f32 v160, s40, v224
v_mul_f32 v161, s40, v225
v_mul_f32 v162, s40, v226
v_mul_f32 v163, s40, v227
v_mul_f32 v168, s41, v240
v_mul_f32 v169, s41, v241
v_mul_f32 v170, s41, v242
v_mul_f32 v171, s41, v243
v_min_f32 v160, s42, v160
v_min_f32 v161, s42, v161
v_min_f32 v162, s42, v162
v_min_f32 v163, s42, v163
v_min_f32 v168, s43, v168
v_min_f32 v169, s43, v169
v_min_f32 v170, s43, v170
v_min_f32 v171, s43, v171
v_exp_f32 v160, v160
v_exp_f32 v161, v161
v_exp_f32 v162, v162
v_exp_f32 v163, v163
v_exp_f32 v168, v168
v_exp_f32 v169, v169
v_exp_f32 v170, v170
v_exp_f32 v171, v171
v_add_f32 v164, 1.0, v160
v_add_f32 v165, 1.0, v161
v_add_f32 v166, 1.0, v162
v_add_f32 v167, 1.0, v163
v_fma_f32 v168, v168, v164, v164
v_fma_f32 v169, v169, v165, v165
v_fma_f32 v170, v170, v166, v166
v_fma_f32 v171, v171, v167, v167
v_rcp_f32 v168, v168
v_rcp_f32 v169, v169
v_rcp_f32 v170, v170
v_rcp_f32 v171, v171
v_add_f32 v160, -1.0, v160
v_add_f32 v161, -1.0, v161
v_add_f32 v162, -1.0, v162
v_add_f32 v163, -1.0, v163
v_mul_f32 v160, v160, v168
v_mul_f32 v161, v161, v169
v_mul_f32 v162, v162, v170
v_mul_f32 v163, v163, v171
v_cvt_pk_bf16_f32 v184, v160, v161
v_cvt_pk_bf16_f32 v185, v162, v163
buffer_store_dwordx2 v[184:185], v13, s[20:23], 0 offen offset:0
v_mul_f32 v160, s40, v228
v_mul_f32 v161, s40, v229
v_mul_f32 v162, s40, v230
v_mul_f32 v163, s40, v231
v_mul_f32 v168, s41, v244
v_mul_f32 v169, s41, v245
v_mul_f32 v170, s41, v246
v_mul_f32 v171, s41, v247
v_min_f32 v160, s42, v160
v_min_f32 v161, s42, v161
v_min_f32 v162, s42, v162
v_min_f32 v163, s42, v163
v_min_f32 v168, s43, v168
v_min_f32 v169, s43, v169
v_min_f32 v170, s43, v170
v_min_f32 v171, s43, v171
v_exp_f32 v160, v160
v_exp_f32 v161, v161
v_exp_f32 v162, v162
v_exp_f32 v163, v163
v_exp_f32 v168, v168
v_exp_f32 v169, v169
v_exp_f32 v170, v170
v_exp_f32 v171, v171
v_add_f32 v164, 1.0, v160
v_add_f32 v165, 1.0, v161
v_add_f32 v166, 1.0, v162
v_add_f32 v167, 1.0, v163
v_fma_f32 v168, v168, v164, v164
v_fma_f32 v169, v169, v165, v165
v_fma_f32 v170, v170, v166, v166
v_fma_f32 v171, v171, v167, v167
v_rcp_f32 v168, v168
v_rcp_f32 v169, v169
v_rcp_f32 v170, v170
v_rcp_f32 v171, v171
v_add_f32 v160, -1.0, v160
v_add_f32 v161, -1.0, v161
v_add_f32 v162, -1.0, v162
v_add_f32 v163, -1.0, v163
v_mul_f32 v160, v160, v168
v_mul_f32 v161, v161, v169
v_mul_f32 v162, v162, v170
v_mul_f32 v163, v163, v171
v_cvt_pk_bf16_f32 v186, v160, v161
v_cvt_pk_bf16_f32 v187, v162, v163
buffer_store_dwordx2 v[186:187], v13, s[20:23], 0 offen offset:16
v_mul_f32 v160, s40, v232
v_mul_f32 v161, s40, v233
v_mul_f32 v162, s40, v234
v_mul_f32 v163, s40, v235
v_mul_f32 v168, s41, v248
v_mul_f32 v169, s41, v249
v_mul_f32 v170, s41, v250
v_mul_f32 v171, s41, v251
v_min_f32 v160, s42, v160
v_min_f32 v161, s42, v161
v_min_f32 v162, s42, v162
v_min_f32 v163, s42, v163
v_min_f32 v168, s43, v168
v_min_f32 v169, s43, v169
v_min_f32 v170, s43, v170
v_min_f32 v171, s43, v171
v_exp_f32 v160, v160
v_exp_f32 v161, v161
v_exp_f32 v162, v162
v_exp_f32 v163, v163
v_exp_f32 v168, v168
v_exp_f32 v169, v169
v_exp_f32 v170, v170
v_exp_f32 v171, v171
v_add_f32 v164, 1.0, v160
v_add_f32 v165, 1.0, v161
v_add_f32 v166, 1.0, v162
v_add_f32 v167, 1.0, v163
v_fma_f32 v168, v168, v164, v164
v_fma_f32 v169, v169, v165, v165
v_fma_f32 v170, v170, v166, v166
v_fma_f32 v171, v171, v167, v167
v_rcp_f32 v168, v168
v_rcp_f32 v169, v169
v_rcp_f32 v170, v170
v_rcp_f32 v171, v171
v_add_f32 v160, -1.0, v160
v_add_f32 v161, -1.0, v161
v_add_f32 v162, -1.0, v162
v_add_f32 v163, -1.0, v163
v_mul_f32 v160, v160, v168
v_mul_f32 v161, v161, v169
v_mul_f32 v162, v162, v170
v_mul_f32 v163, v163, v171
v_cvt_pk_bf16_f32 v188, v160, v161
v_cvt_pk_bf16_f32 v189, v162, v163
buffer_store_dwordx2 v[188:189], v13, s[20:23], 0 offen offset:32
v_mul_f32 v160, s40, v236
v_mul_f32 v161, s40, v237
v_mul_f32 v162, s40, v238
v_mul_f32 v163, s40, v239
v_mul_f32 v168, s41, v252
v_mul_f32 v169, s41, v253
v_mul_f32 v170, s41, v254
v_mul_f32 v171, s41, v255
v_min_f32 v160, s42, v160
v_min_f32 v161, s42, v161
v_min_f32 v162, s42, v162
v_min_f32 v163, s42, v163
v_min_f32 v168, s43, v168
v_min_f32 v169, s43, v169
v_min_f32 v170, s43, v170
v_min_f32 v171, s43, v171
v_exp_f32 v160, v160
v_exp_f32 v161, v161
v_exp_f32 v162, v162
v_exp_f32 v163, v163
v_exp_f32 v168, v168
v_exp_f32 v169, v169
v_exp_f32 v170, v170
v_exp_f32 v171, v171
v_add_f32 v164, 1.0, v160
v_add_f32 v165, 1.0, v161
v_add_f32 v166, 1.0, v162
v_add_f32 v167, 1.0, v163
v_fma_f32 v168, v168, v164, v164
v_fma_f32 v169, v169, v165, v165
v_fma_f32 v170, v170, v166, v166
v_fma_f32 v171, v171, v167, v167
v_rcp_f32 v168, v168
v_rcp_f32 v169, v169
v_rcp_f32 v170, v170
v_rcp_f32 v171, v171
v_add_f32 v160, -1.0, v160
v_add_f32 v161, -1.0, v161
v_add_f32 v162, -1.0, v162
v_add_f32 v163, -1.0, v163
v_mul_f32 v160, v160, v168
v_mul_f32 v161, v161, v169
v_mul_f32 v162, v162, v170
v_mul_f32 v163, v163, v171
v_cvt_pk_bf16_f32 v190, v160, v161
v_cvt_pk_bf16_f32 v191, v162, v163
buffer_store_dwordx2 v[190:191], v13, s[20:23], 0 offen offset:48
s_waitcnt vmcnt(0)
L_end:
s_endpgm
.globl wn_out_kernel
.p2align 8
.type wn_out_kernel,@function
wn_out_kernel:
s_cmp_ge_u32 s2, 256
s_cbranch_scc1 L2_end
s_and_b32 s24, s2, 7
s_lshr_b32 s25, s2, 4
s_lshl_b32 s25, s25, 3
s_add_u32 s24, s24, s25
s_cmp_ge_u32 s24, 125
s_cbranch_scc1 L2_end
s_lshr_b32 s27, s2, 3
s_and_b32 s27, s27, 1
s_load_dwordx2 s[4:5], s[0:1], 16
s_load_dwordx4 s[8:11], s[0:1], 24
s_load_dwordx2 s[6:7], s[0:1], 40
v_lshrrev_b32 v1, 6, v0
v_and_b32 v2, 63, v0
s_nop 0
v_readfirstlane_b32 s31, v1
s_waitcnt lgkmcnt(0)
s_mov_b32 s12, s6
s_mov_b32 s13, s7
s_mov_b32 s14, 4096000
s_mov_b32 s15, 0x00020000
s_mov_b32 s16, s4
s_mov_b32 s17, s5
s_mov_b32 s18, 131072
s_mov_b32 s19, 0x00020000
s_mov_b32 s20, s8
s_mov_b32 s21, s9
s_mov_b32 s22, 4096000
s_mov_b32 s23, 0x00020000
s_lshr_b32 s32, s31, 1
s_and_b32 s33, s31, 1
s_lshl_b32 s34, s24, 15
v_lshlrev_b32 v3, 4, v0
v_add_u32 v3, s34, v3
s_mov_b32 s36, 0
buffer_load_dwordx4 v[64:67], v3, s[12:15], s36 offen
s_mov_b32 s36, 4096
buffer_load_dwordx4 v[68:71], v3, s[12:15], s36 offen
s_mov_b32 s36, 8192
buffer_load_dwordx4 v[72:75], v3, s[12:15], s36 offen
s_mov_b32 s36, 12288
buffer_load_dwordx4 v[76:79], v3, s[12:15], s36 offen
s_mov_b32 s36, 16384
buffer_load_dwordx4 v[80:83], v3, s[12:15], s36 offen
s_mov_b32 s36, 20480
buffer_load_dwordx4 v[84:87], v3, s[12:15], s36 offen
s_mov_b32 s36, 24576
buffer_load_dwordx4 v[88:91], v3, s[12:15], s36 offen
s_mov_b32 s36, 28672
buffer_load_dwordx4 v[92:95], v3, s[12:15], s36 offen
v_and_b32 v4, 15, v0
v_lshrrev_b32 v5, 4, v0
v_and_b32 v6, 3, v5
v_lshlrev_b32 v6, 2, v6
v_xor_b32 v4, v4, v6
v_lshlrev_b32 v4, 4, v4
v_lshlrev_b32 v5, 9, v5
v_add_u32 v4, v4, v5
s_lshl_b32 s35, s27, 8
v_add_u32 v4, s35, v4
v_lshlrev_b32 v5, 4, v0
v_add_u32 v5, 34048, v5
s_mov_b32 s36, 0
buffer_load_dwordx4 v[96:99], v4, s[16:19], s36 offen
s_mov_b32 s36, 8192
buffer_load_dwordx4 v[100:103], v4, s[16:19], s36 offen
s_mov_b32 s36, 16384
buffer_load_dwordx4 v[104:107], v4, s[16:19], s36 offen
s_mov_b32 s36, 24576
buffer_load_dwordx4 v[108:111], v4, s[16:19], s36 offen
s_mov_b32 s36, 32768
buffer_load_dwordx4 v[112:115], v4, s[16:19], s36 offen
s_mov_b32 s36, 40960
buffer_load_dwordx4 v[116:119], v4, s[16:19], s36 offen
s_mov_b32 s36, 49152
buffer_load_dwordx4 v[120:123], v4, s[16:19], s36 offen
s_mov_b32 s36, 57344
buffer_load_dwordx4 v[124:127], v4, s[16:19], s36 offen
s_mov_b32 s36, 65536
buffer_load_dwordx4 v[128:131], v4, s[16:19], s36 offen
s_mov_b32 s36, 73728
buffer_load_dwordx4 v[132:135], v4, s[16:19], s36 offen
s_mov_b32 s36, 81920
buffer_load_dwordx4 v[136:139], v4, s[16:19], s36 offen
s_mov_b32 s36, 90112
buffer_load_dwordx4 v[140:143], v4, s[16:19], s36 offen
s_mov_b32 s36, 98304
buffer_load_dwordx4 v[144:147], v4, s[16:19], s36 offen
s_mov_b32 s36, 106496
buffer_load_dwordx4 v[148:151], v4, s[16:19], s36 offen
s_mov_b32 s36, 114688
buffer_load_dwordx4 v[152:155], v4, s[16:19], s36 offen
s_mov_b32 s36, 122880
buffer_load_dwordx4 v[156:159], v4, s[16:19], s36 offen
v_lshrrev_b32 v6, 5, v0
v_mul_u32_u24 v6, 528, v6
v_and_b32 v7, 31, v0
v_lshlrev_b32 v7, 4, v7
v_add_u32 v6, v6, v7
v_and_b32 v8, 31, v2
s_lshl_b32 s36, s32, 5
v_add_u32 v8, s36, v8
v_mul_u32_u24 v8, 528, v8
v_lshrrev_b32 v9, 5, v2
v_lshlrev_b32 v10, 4, v9
v_add_u32 v8, v8, v10
v_and_b32 v10, 15, v2
v_lshrrev_b32 v10, 2, v10
v_and_b32 v11, 3, v2
v_lshrrev_b32 v12, 4, v2
v_and_b32 v12, 1, v12
v_lshlrev_b32 v13, 1, v12
v_lshrrev_b32 v14, 1, v11
v_add_u32 v13, v13, v14
s_lshl_b32 s36, s33, 3
v_add_u32 v13, s36, v13
v_lshlrev_b32 v14, 2, v10
v_xor_b32 v13, v13, v14
v_lshlrev_b32 v13, 4, v13
v_and_b32 v14, 1, v11
v_lshlrev_b32 v14, 3, v14
v_add_u32 v13, v13, v14
v_lshlrev_b32 v14, 3, v9
v_add_u32 v14, v14, v10
v_lshlrev_b32 v14, 8, v14
v_add_u32 v13, v13, v14
v_add_u32 v10, 34048, v13
v_xor_b32 v11, 64, v10
v_mov_b32 v192, 0
v_mov_b32 v193, 0
v_mov_b32 v194, 0
v_mov_b32 v195, 0
v_mov_b32 v196, 0
v_mov_b32 v197, 0
v_mov_b32 v198, 0
v_mov_b32 v199, 0
v_mov_b32 v200, 0
v_mov_b32 v201, 0
v_mov_b32 v202, 0
v_mov_b32 v203, 0
v_mov_b32 v204, 0
v_mov_b32 v205, 0
v_mov_b32 v206, 0
v_mov_b32 v207, 0
v_mov_b32 v208, 0
v_mov_b32 v209, 0
v_mov_b32 v210, 0
v_mov_b32 v211, 0
v_mov_b32 v212, 0
v_mov_b32 v213, 0
v_mov_b32 v214, 0
v_mov_b32 v215, 0
v_mov_b32 v216, 0
v_mov_b32 v217, 0
v_mov_b32 v218, 0
v_mov_b32 v219, 0
v_mov_b32 v220, 0
v_mov_b32 v221, 0
v_mov_b32 v222, 0
v_mov_b32 v223, 0
s_waitcnt vmcnt(16)
ds_write_b128 v6, v[64:67] offset:0
ds_write_b128 v6, v[68:71] offset:4224
ds_write_b128 v6, v[72:75] offset:8448
ds_write_b128 v6, v[76:79] offset:12672
ds_write_b128 v6, v[80:83] offset:16896
ds_write_b128 v6, v[84:87] offset:21120
ds_write_b128 v6, v[88:91] offset:25344
ds_write_b128 v6, v[92:95] offset:29568
s_waitcnt vmcnt(15)
ds_write_b128 v5, v[96:99] offset:0
s_waitcnt vmcnt(14)
ds_write_b128 v5, v[100:103] offset:4096
s_waitcnt vmcnt(13)
ds_write_b128 v5, v[104:107] offset:8192
s_waitcnt vmcnt(12)
ds_write_b128 v5, v[108:111] offset:12288
s_waitcnt vmcnt(11)
ds_write_b128 v5, v[112:115] offset:16384
s_waitcnt vmcnt(10)
ds_write_b128 v5, v[116:119] offset:20480
s_waitcnt vmcnt(9)
ds_write_b128 v5, v[120:123] offset:24576
s_waitcnt vmcnt(8)
ds_write_b128 v5, v[124:127] offset:28672
s_waitcnt vmcnt(7)
ds_write_b128 v5, v[128:131] offset:32768
s_waitcnt vmcnt(6)
ds_write_b128 v5, v[132:135] offset:36864
s_waitcnt vmcnt(5)
ds_write_b128 v5, v[136:139] offset:40960
s_waitcnt vmcnt(4)
ds_write_b128 v5, v[140:143] offset:45056
s_waitcnt vmcnt(3)
ds_write_b128 v5, v[144:147] offset:49152
s_waitcnt vmcnt(2)
ds_write_b128 v5, v[148:151] offset:53248
s_waitcnt vmcnt(1)
ds_write_b128 v5, v[152:155] offset:57344
s_waitcnt vmcnt(0)
ds_write_b128 v5, v[156:159] offset:61440
s_waitcnt lgkmcnt(0)
s_barrier
ds_read_b128 v[160:163], v8 offset:0
ds_read_b64_tr_b16 v[164:165], v10 offset:0
ds_read_b64_tr_b16 v[166:167], v10 offset:1024
ds_read_b64_tr_b16 v[168:169], v11 offset:0
ds_read_b64_tr_b16 v[170:171], v11 offset:1024
ds_read_b128 v[172:175], v8 offset:32
ds_read_b64_tr_b16 v[176:177], v10 offset:4096
ds_read_b64_tr_b16 v[178:179], v10 offset:5120
ds_read_b64_tr_b16 v[180:181], v11 offset:4096
ds_read_b64_tr_b16 v[182:183], v11 offset:5120
s_waitcnt lgkmcnt(5)
v_mfma_f32_32x32x16_bf16 v[192:207], v[164:167], v[160:163], v[192:207]
v_mfma_f32_32x32x16_bf16 v[208:223], v[168:171], v[160:163], v[208:223]
ds_read_b128 v[160:163], v8 offset:64
ds_read_b64_tr_b16 v[164:165], v10 offset:8192
ds_read_b64_tr_b16 v[166:167], v10 offset:9216
ds_read_b64_tr_b16 v[168:169], v11 offset:8192
ds_read_b64_tr_b16 v[170:171], v11 offset:9216
s_waitcnt lgkmcnt(5)
v_mfma_f32_32x32x16_bf16 v[192:207], v[176:179], v[172:175], v[192:207]
v_mfma_f32_32x32x16_bf16 v[208:223], v[180:183], v[172:175], v[208:223]
ds_read_b128 v[172:175], v8 offset:96
ds_read_b64_tr_b16 v[176:177], v10 offset:12288
ds_read_b64_tr_b16 v[178:179], v10 offset:13312
ds_read_b64_tr_b16 v[180:181], v11 offset:12288
ds_read_b64_tr_b16 v[182:183], v11 offset:13312
s_waitcnt lgkmcnt(5)
v_mfma_f32_32x32x16_bf16 v[192:207], v[164:167], v[160:163], v[192:207]
v_mfma_f32_32x32x16_bf16 v[208:223], v[168:171], v[160:163], v[208:223]
ds_read_b128 v[160:163], v8 offset:128
ds_read_b64_tr_b16 v[164:165], v10 offset:16384
ds_read_b64_tr_b16 v[166:167], v10 offset:17408
ds_read_b64_tr_b16 v[168:169], v11 offset:16384
ds_read_b64_tr_b16 v[170:171], v11 offset:17408
s_waitcnt lgkmcnt(5)
v_mfma_f32_32x32x16_bf16 v[192:207], v[176:179], v[172:175], v[192:207]
v_mfma_f32_32x32x16_bf16 v[208:223], v[180:183], v[172:175], v[208:223]
ds_read_b128 v[172:175], v8 offset:160
ds_read_b64_tr_b16 v[176:177], v10 offset:20480
ds_read_b64_tr_b16 v[178:179], v10 offset:21504
ds_read_b64_tr_b16 v[180:181], v11 offset:20480
ds_read_b64_tr_b16 v[182:183], v11 offset:21504
s_waitcnt lgkmcnt(5)
v_mfma_f32_32x32x16_bf16 v[192:207], v[164:167], v[160:163], v[192:207]
v_mfma_f32_32x32x16_bf16 v[208:223], v[168:171], v[160:163], v[208:223]
ds_read_b128 v[160:163], v8 offset:192
ds_read_b64_tr_b16 v[164:165], v10 offset:24576
ds_read_b64_tr_b16 v[166:167], v10 offset:25600
ds_read_b64_tr_b16 v[168:169], v11 offset:24576
ds_read_b64_tr_b16 v[170:171], v11 offset:25600
s_waitcnt lgkmcnt(5)
v_mfma_f32_32x32x16_bf16 v[192:207], v[176:179], v[172:175], v[192:207]
v_mfma_f32_32x32x16_bf16 v[208:223], v[180:183], v[172:175], v[208:223]
ds_read_b128 v[172:175], v8 offset:224
ds_read_b64_tr_b16 v[176:177], v10 offset:28672
ds_read_b64_tr_b16 v[178:179], v10 offset:29696
ds_read_b64_tr_b16 v[180:181], v11 offset:28672
ds_read_b64_tr_b16 v[182:183], v11 offset:29696
s_waitcnt lgkmcnt(5)
v_mfma_f32_32x32x16_bf16 v[192:207], v[164:167], v[160:163], v[192:207]
v_mfma_f32_32x32x16_bf16 v[208:223], v[168:171], v[160:163], v[208:223]
ds_read_b128 v[160:163], v8 offset:256
ds_read_b64_tr_b16 v[164:165], v10 offset:32768
ds_read_b64_tr_b16 v[166:167], v10 offset:33792
ds_read_b64_tr_b16 v[168:169], v11 offset:32768
ds_read_b64_tr_b16 v[170:171], v11 offset:33792
s_waitcnt lgkmcnt(5)
v_mfma_f32_32x32x16_bf16 v[192:207], v[176:179], v[172:175], v[192:207]
v_mfma_f32_32x32x16_bf16 v[208:223], v[180:183], v[172:175], v[208:223]
ds_read_b128 v[172:175], v8 offset:288
ds_read_b64_tr_b16 v[176:177], v10 offset:36864
ds_read_b64_tr_b16 v[178:179], v10 offset:37888
ds_read_b64_tr_b16 v[180:181], v11 offset:36864
ds_read_b64_tr_b16 v[182:183], v11 offset:37888
s_waitcnt lgkmcnt(5)
v_mfma_f32_32x32x16_bf16 v[192:207], v[164:167], v[160:163], v[192:207]
v_mfma_f32_32x32x16_bf16 v[208:223], v[168:171], v[160:163], v[208:223]
ds_read_b128 v[160:163], v8 offset:320
ds_read_b64_tr_b16 v[164:165], v10 offset:40960
ds_read_b64_tr_b16 v[166:167], v10 offset:41984
ds_read_b64_tr_b16 v[168:169], v11 offset:40960
ds_read_b64_tr_b16 v[170:171], v11 offset:41984
s_waitcnt lgkmcnt(5)
v_mfma_f32_32x32x16_bf16 v[192:207], v[176:179], v[172:175], v[192:207]
v_mfma_f32_32x32x16_bf16 v[208:223], v[180:183], v[172:175], v[208:223]
ds_read_b128 v[172:175], v8 offset:352
ds_read_b64_tr_b16 v[176:177], v10 offset:45056
ds_read_b64_tr_b16 v[178:179], v10 offset:46080
ds_read_b64_tr_b16 v[180:181], v11 offset:45056
ds_read_b64_tr_b16 v[182:183], v11 offset:46080
s_waitcnt lgkmcnt(5)
v_mfma_f32_32x32x16_bf16 v[192:207], v[164:167], v[160:163], v[192:207]
v_mfma_f32_32x32x16_bf16 v[208:223], v[168:171], v[160:163], v[208:223]
ds_read_b128 v[160:163], v8 offset:384
ds_read_b64_tr_b16 v[164:165], v10 offset:49152
ds_read_b64_tr_b16 v[166:167], v10 offset:50176
ds_read_b64_tr_b16 v[168:169], v11 offset:49152
ds_read_b64_tr_b16 v[170:171], v11 offset:50176
s_waitcnt lgkmcnt(5)
v_mfma_f32_32x32x16_bf16 v[192:207], v[176:179], v[172:175], v[192:207]
v_mfma_f32_32x32x16_bf16 v[208:223], v[180:183], v[172:175], v[208:223]
ds_read_b128 v[172:175], v8 offset:416
ds_read_b64_tr_b16 v[176:177], v10 offset:53248
ds_read_b64_tr_b16 v[178:179], v10 offset:54272
ds_read_b64_tr_b16 v[180:181], v11 offset:53248
ds_read_b64_tr_b16 v[182:183], v11 offset:54272
s_waitcnt lgkmcnt(5)
v_mfma_f32_32x32x16_bf16 v[192:207], v[164:167], v[160:163], v[192:207]
v_mfma_f32_32x32x16_bf16 v[208:223], v[168:171], v[160:163], v[208:223]
ds_read_b128 v[160:163], v8 offset:448
ds_read_b64_tr_b16 v[164:165], v10 offset:57344
ds_read_b64_tr_b16 v[166:167], v10 offset:58368
ds_read_b64_tr_b16 v[168:169], v11 offset:57344
ds_read_b64_tr_b16 v[170:171], v11 offset:58368
s_waitcnt lgkmcnt(5)
v_mfma_f32_32x32x16_bf16 v[192:207], v[176:179], v[172:175], v[192:207]
v_mfma_f32_32x32x16_bf16 v[208:223], v[180:183], v[172:175], v[208:223]
ds_read_b128 v[172:175], v8 offset:480
ds_read_b64_tr_b16 v[176:177], v10 offset:61440
ds_read_b64_tr_b16 v[178:179], v10 offset:62464
ds_read_b64_tr_b16 v[180:181], v11 offset:61440
ds_read_b64_tr_b16 v[182:183], v11 offset:62464
s_waitcnt lgkmcnt(5)
v_mfma_f32_32x32x16_bf16 v[192:207], v[164:167], v[160:163], v[192:207]
v_mfma_f32_32x32x16_bf16 v[208:223], v[168:171], v[160:163], v[208:223]
s_waitcnt lgkmcnt(0)
v_mfma_f32_32x32x16_bf16 v[192:207], v[176:179], v[172:175], v[192:207]
v_mfma_f32_32x32x16_bf16 v[208:223], v[180:183], v[172:175], v[208:223]
s_nop 15
s_nop 7
v_and_b32 v12, 31, v2
s_lshl_b32 s36, s24, 6
s_lshl_b32 s37, s32, 5
s_add_u32 s36, s36, s37
v_add_u32 v12, s36, v12
v_lshlrev_b32 v12, 9, v12
s_lshl_b32 s36, s27, 8
s_lshl_b32 s37, s33, 7
s_add_u32 s36, s36, s37
v_lshlrev_b32 v13, 3, v9
v_add_u32 v13, s36, v13
v_add_u32 v12, v12, v13
v_cvt_pk_bf16_f32 v64, v192, v193
v_cvt_pk_bf16_f32 v65, v194, v195
v_cvt_pk_bf16_f32 v66, v196, v197
v_cvt_pk_bf16_f32 v67, v198, v199
v_cvt_pk_bf16_f32 v68, v200, v201
v_cvt_pk_bf16_f32 v69, v202, v203
v_cvt_pk_bf16_f32 v70, v204, v205
v_cvt_pk_bf16_f32 v71, v206, v207
v_cvt_pk_bf16_f32 v72, v208, v209
v_cvt_pk_bf16_f32 v73, v210, v211
v_cvt_pk_bf16_f32 v74, v212, v213
v_cvt_pk_bf16_f32 v75, v214, v215
v_cvt_pk_bf16_f32 v76, v216, v217
v_cvt_pk_bf16_f32 v77, v218, v219
v_cvt_pk_bf16_f32 v78, v220, v221
v_cvt_pk_bf16_f32 v79, v222, v223
buffer_store_dwordx2 v[64:65], v12, s[20:23], 0 offen offset:0
buffer_store_dwordx2 v[66:67], v12, s[20:23], 0 offen offset:16
buffer_store_dwordx2 v[68:69], v12, s[20:23], 0 offen offset:32
buffer_store_dwordx2 v[70:71], v12, s[20:23], 0 offen offset:48
buffer_store_dwordx2 v[72:73], v12, s[20:23], 0 offen offset:64
buffer_store_dwordx2 v[74:75], v12, s[20:23], 0 offen offset:80
buffer_store_dwordx2 v[76:77], v12, s[20:23], 0 offen offset:96
buffer_store_dwordx2 v[78:79], v12, s[20:23], 0 offen offset:112
s_waitcnt vmcnt(0)
L2_end:
s_endpgm
.section .rodata,"a"
.p2align 6
.amdhsa_kernel wn_conv_kernel
  .amdhsa_next_free_vgpr 256
  .amdhsa_next_free_sgpr 96
  .amdhsa_accum_offset 256
  .amdhsa_group_segment_fixed_size 0
  .amdhsa_kernarg_size 48
  .amdhsa_user_sgpr_count 2
  .amdhsa_user_sgpr_kernarg_segment_ptr 1
  .amdhsa_system_sgpr_workgroup_id_x 1
.end_amdhsa_kernel
.p2align 6
.amdhsa_kernel wn_out_kernel
  .amdhsa_next_free_vgpr 256
  .amdhsa_next_free_sgpr 96
  .amdhsa_accum_offset 256
  .amdhsa_group_segment_fixed_size 0
  .amdhsa_kernarg_size 48
  .amdhsa_user_sgpr_count 2
  .amdhsa_user_sgpr_kernarg_segment_ptr 1
  .amdhsa_system_sgpr_workgroup_id_x 1
.end_amdhsa_kernel
```
